```python
import torch

def _softmax(x, axis=-1):
    return torch.softmax(x, dim=axis)
def _gelu(x):
    return torch.nn.functional.gelu(x, approximate="tanh")
def _silu(x):
    return torch.nn.functional.silu(x)
def _sigmoid(x):
    return torch.sigmoid(x)
def _layernorm(x, axis=-1, eps=1e-5):
    m = x.mean(dim=axis, keepdim=True)
    v = x.var(dim=axis, keepdim=True, unbiased=False)
    return (x - m) / torch.sqrt(v + eps)
def _scatter_add(tgt, idx, src, axis=0):
    return tgt.clone().index_add_(axis, idx, src)
def _segment_sum(src, seg, n):
    out = torch.zeros((n,) + src.shape[1:], dtype=src.dtype)
    return out.index_add_(0, seg, src)
def _pad(x, pw):
    flat = tuple(v for pair in reversed(pw) for v in pair)
    return torch.nn.functional.pad(x, flat)

kernel_name = 'interleave_layers__spectral_gfnet__spectral_gfnet__prompt'

def setup_inputs():

    _w = (lambda a: (lambda t: t.to(torch.bfloat16) if t.is_floating_point() else t)(torch.as_tensor(a)))
    def _A_setup():
        B, S, D = 1, 2048, 1024
        Df = D // 2 + 1
        return {
            "x": _w((lambda *s: torch.randn(*s, dtype=torch.bfloat16) * 0.05)(B, S, D)),
            "w_r": _w((lambda *s: torch.randn(*s, dtype=torch.bfloat16) * 0.2)(S, Df) * 0.02),
            "w_i": _w((lambda *s: torch.randn(*s, dtype=torch.bfloat16) * 0.2)(S, Df) * 0.02),
        }
    _A_in = _A_setup()

    def _B_setup():
        B, S, D = 1, 2048, 1024
        Df = D // 2 + 1
        return {
            "x": _w((lambda *s: torch.randn(*s, dtype=torch.bfloat16) * 0.05)(B, S, D)),
            "w_r": _w((lambda *s: torch.randn(*s, dtype=torch.bfloat16) * 0.2)(S, Df) * 0.02),
            "w_i": _w((lambda *s: torch.randn(*s, dtype=torch.bfloat16) * 0.2)(S, Df) * 0.02),
        }
    _B_in = _B_setup()

    return {
        "A_x": _A_in["x"],
        "A_w_r": _A_in["w_r"],
        "A_w_i": _A_in["w_i"],
        "B_x": _B_in["x"],
        "B_w_r": _B_in["w_r"],
        "B_w_i": _B_in["w_i"],
    }

def reference(A_x, A_w_r, A_w_i, B_x, B_w_r, B_w_i):
    def _A_ref(x, w_r, w_i):
        B, S, D = x.shape
        X = (lambda x, axes=(-2,-1): torch.fft.rfft2(x.float(), dim=axes))(x, axes=(-2, -1))
        W = w_r + 1j * w_i
        X = X * W
        y = (lambda x, s, axes=(-2,-1): torch.fft.irfft2(x, s=s, dim=axes).to(torch.bfloat16))(X, (S, D), axes=(-2, -1))
        return y

    def _B_ref(x, w_r, w_i):
        B, S, D = x.shape
        X = (lambda x, axes=(-2,-1): torch.fft.rfft2(x.float(), dim=axes))(x, axes=(-2, -1))
        W = w_r + 1j * w_i
        X = X * W
        y = (lambda x, s, axes=(-2,-1): torch.fft.irfft2(x, s=s, dim=axes).to(torch.bfloat16))(X, (S, D), axes=(-2, -1))
        return y

    x = A_x
    x = x + _A_ref(_layernorm(x, axis=-1), A_w_r, A_w_i)
    x = x + _B_ref(_layernorm(x, axis=-1), B_w_r, B_w_i)
    x = x + _A_ref(_layernorm(x, axis=-1), A_w_r, A_w_i)
    x = x + _B_ref(_layernorm(x, axis=-1), B_w_r, B_w_i)
    return x
```

```asm
; @launch kernel=interleave_layers__spectral_gfnet__spectral_gfnet__prompt_kernel grid=(256,1,1) block=(256,1,1) lds=142592
.amdgcn_target "amdgcn-amd-amdhsa--gfx950"
.text
.globl interleave_layers__spectral_gfnet__spectral_gfnet__prompt_kernel
.p2align 8
.type interleave_layers__spectral_gfnet__spectral_gfnet__prompt_kernel,@function
interleave_layers__spectral_gfnet__spectral_gfnet__prompt_kernel:
L_code_begin:
    s_cmp_ge_u32 s2, 256
    s_cbranch_scc1 L_end
    s_load_dwordx16 s[64:79], s[0:1], 0
    s_load_dwordx2 s[80:81], s[0:1], 64
    s_getpc_b64 s[82:83]
    v_lshlrev_b32_e64 v30, 7, v0
    v_min_u32 v30, L_end-L_code_begin-64, v30
    global_load_dword a255, v30, s[82:83]
    v_and_b32 v1, 63, v0
    v_lshrrev_b32 v30, 6, v0
    v_lshlrev_b32 v6, 4, v0
    v_readfirstlane_b32 s36, v30
    v_lshrrev_b32 v3, 5, v1
    v_lshlrev_b32 v5, 4, v1
    v_and_b32_e64 v2, 3, v0
    v_bfe_u32 v30, v0, 3, 2
    v_lshl_or_b32 v2, v30, 2, v2
    v_bfe_u32 v30, v0, 2, 1
    v_lshl_or_b32 v2, v30, 4, v2
    v_lshlrev_b32 v7, 6, v2
    v_lshl_add_u32 v7, v3, 5, v7
    s_lshr_b32 s41, s2, 5
    s_lshl_b32 s41, s41, 2
    s_add_u32 s41, s41, s36
    s_lshl_b32 s41, s41, 5
    s_and_b32 s42, s2, 31
    s_add_u32 s41, s41, s42
    s_lshl_b32 s50, s41, 11
    s_add_u32 s51, s50, 0x200000
    s_lshr_b32 s41, s2, 2
    s_and_b32 s41, s41, 7
    s_lshr_b32 s42, s41, 1
    s_lshl_b32 s42, s42, 2
    s_and_b32 s43, s41, 1
    s_lshl_b32 s43, s43, 4
    s_or_b32 s42, s42, s43
    s_lshl_b32 s42, s42, 1
    s_lshr_b32 s43, s2, 1
    s_and_b32 s43, s43, 1
    s_add_u32 s42, s42, s43
    s_lshr_b32 s43, s2, 5
    s_lshl_b32 s43, s43, 8
    s_add_u32 s56, s42, s43
    s_and_b32 s42, s2, 1
    s_lshl_b32 s42, s42, 1
    s_lshr_b32 s43, s2, 1
    s_and_b32 s43, s43, 1
    s_add_u32 s42, s42, s43
    s_lshl_b32 s57, s42, 12
    s_lshr_b32 s42, s2, 5
    s_and_b32 s43, s42, 3
    s_lshl_b32 s43, s43, 10
    s_add_u32 s57, s57, s43
    s_lshr_b32 s42, s42, 2
    s_lshl_b32 s42, s42, 9
    s_add_u32 s57, s57, s42
    s_lshl_b32 s41, s41, 6
    s_add_u32 s57, s57, s41
    s_lshl_b32 s41, s36, 6
    s_add_u32 s41, s41, s56
    s_mul_i32 s41, s41, 1026
    s_and_b32 s42, s2, 1
    s_lshl_b32 s42, s42, 9
    s_add_u32 s41, s41, s42
    s_and_b32 s41, s41, -4
    v_and_b32 v28, 31, v1
    v_lshlrev_b32 v28, 4, v28
    v_mul_u32_u24 v29, 2052, v3
    v_add_u32 v28, v28, v29
    v_and_b32_e64 v29, 3, v1
    v_mul_u32_u24 v29, 2052, v29
    s_add_u32 s42, s41, 4104
    s_waitcnt lgkmcnt(0)
    s_load_dword s95, s[80:81], 0
    s_mov_b32 s4, s64
    s_mov_b32 s5, s65
    s_nop 0
    s_mov_b32 s6, 4194304
    s_mov_b32 s7, 0x00020000
    buffer_load_dwordx4 a[80:83], v7, s[4:7], s50 offen offset:0
    buffer_load_dwordx4 a[84:87], v7, s[4:7], s50 offen offset:16
    buffer_load_dwordx4 a[88:91], v7, s[4:7], s51 offen offset:0
    buffer_load_dwordx4 a[92:95], v7, s[4:7], s51 offen offset:16
    s_mov_b32 s92, s41
    s_mov_b32 s93, s42
    v_mov_b32 v18, v28
    v_mov_b32 v19, v29
    s_mov_b32 s12, s80
    s_mov_b32 s13, s81
    s_mov_b32 s14, 134217728
    s_mov_b32 s15, 0x00020000
    s_lshl_b32 s58, s2, 14
    s_and_b32 s59, s2, 127
    s_lshl_b32 s59, s59, 14
    s_lshr_b32 s42, s2, 7
    s_lshl_b32 s42, s42, 13
    s_add_u32 s60, s59, s42
    v_mov_b32 v24, -1
    v_mov_b32 v25, -1
    v_mov_b32 v26, -1
    v_mov_b32 v27, -1
    s_add_u32 s42, s60, 2097152
    s_add_u32 s47, s42, 0
    buffer_store_dwordx4 v[24:27], v6, s[12:15], s47 offen sc1
    s_add_u32 s47, s42, 4096
    buffer_store_dwordx4 v[24:27], v6, s[12:15], s47 offen sc1
    s_mul_i32 s43, s2, 768
    s_add_u32 s43, s43, 286720
    v_cmp_gt_u32 vcc, 48, v0
    v_mov_b32 v29, 0x7ffffff0
    s_nop 0
    v_cndmask_b32 v30, v29, v6, vcc
    buffer_store_dwordx4 v[24:27], v30, s[12:15], s43 offen sc1
    s_mov_b32 s20, s66
    s_mov_b32 s21, s67
    s_mov_b32 s22, 2101248
    s_mov_b32 s23, 0x00020000
    s_mov_b32 s24, s68
    s_mov_b32 s25, s69
    s_mov_b32 s26, 2101248
    s_mov_b32 s27, 0x00020000
    s_mov_b32 s28, s72
    s_mov_b32 s29, s73
    s_mov_b32 s30, 2101248
    s_mov_b32 s31, 0x00020000
    s_mov_b32 s32, s74
    s_mov_b32 s33, s75
    s_mov_b32 s34, 2101248
    s_mov_b32 s35, 0x00020000
    s_cmp_eq_u32 s36, 1
    s_cselect_b32 s16, s72, s66
    s_cselect_b32 s17, s73, s67
    s_cselect_b32 s84, s74, s68
    s_cselect_b32 s85, s75, s69
    s_mov_b32 s18, 2101248
    s_mov_b32 s19, 0x00020000
    s_mov_b32 s86, 2101248
    s_mov_b32 s87, 0x00020000
    v_bfe_u32 v30, v1, 2, 2
    v_and_b32 v31, 3, v1
    v_lshlrev_b32 v31, 6, v31
    v_lshl_add_u32 v30, v30, 1, v31
    v_add_u32_e64 v30, s56, v30
    v_sub_u32 v31, 0x800, v30
    v_and_b32 v31, 0x7ff, v31
    v_mul_u32_u24 v31, 1026, v31
    s_and_b32 s43, s2, 1
    s_lshl_b32 s43, s43, 10
    v_and_b32 v27, 0xaf, v0
    v_and_b32 v30, 0xb0, v0
    v_cmp_eq_u32 vcc, 0, v30
    v_mov_b32 v27, 0x7ffffff0
    s_nop 0
    v_cndmask_b32 v31, v27, v31, vcc
    buffer_load_ushort a246, v31, s[16:19], s43 offen
    buffer_load_ushort a247, v31, s[84:87], s43 offen
    s_mov_b32 s8, s76
    s_mov_b32 s9, s77
    s_mov_b32 s10, 4194304
    s_mov_b32 s11, 0x00020000
    s_and_b32 s37, s36, 1
    s_lshr_b32 s38, s36, 1
    s_or_b32 s41, s2, s38
    s_cmp_eq_u32 s41, 0
    s_cselect_b32 s39, 1, 0
    v_cvt_f32_u32 v4, v2
    v_cvt_f32_u32 v8, v3
    v_mul_f32 v8, 0x41800000, v8
    v_lshlrev_b32 v28, 4, v3
    v_sub_u32 v28, v2, v28
    v_and_b32 v27, 1, v28
    v_lshlrev_b32 v27, 4, v27
    v_mov_b32 v26, 0x3f80
    v_lshlrev_b32 v26, v27, v26
    v_ashrrev_i32 v28, 1, v28
    v_cmp_eq_u32 vcc, 0, v28
    s_nop 1
    v_cndmask_b32 v240, 0, v26, vcc
    v_cmp_eq_u32 vcc, 1, v28
    s_nop 1
    v_cndmask_b32 v241, 0, v26, vcc
    v_cmp_eq_u32 vcc, 2, v28
    s_nop 1
    v_cndmask_b32 v242, 0, v26, vcc
    v_cmp_eq_u32 vcc, 3, v28
    s_nop 1
    v_cndmask_b32 v243, 0, v26, vcc
    v_cmp_eq_u32 vcc, 4, v28
    s_nop 1
    v_cndmask_b32 v244, 0, v26, vcc
    v_cmp_eq_u32 vcc, 5, v28
    s_nop 1
    v_cndmask_b32 v245, 0, v26, vcc
    v_cmp_eq_u32 vcc, 6, v28
    s_nop 1
    v_cndmask_b32 v246, 0, v26, vcc
    v_cmp_eq_u32 vcc, 7, v28
    s_nop 1
    v_cndmask_b32 v247, 0, v26, vcc
    v_accvgpr_write_b32 a72, v240
    v_accvgpr_write_b32 a73, v241
    v_accvgpr_write_b32 a74, v242
    v_accvgpr_write_b32 a75, v243
    v_accvgpr_write_b32 a76, v244
    v_accvgpr_write_b32 a77, v245
    v_accvgpr_write_b32 a78, v246
    v_accvgpr_write_b32 a79, v247
    v_mul_f32 v28, 0x3d000000, v4
    v_mul_f32 v27, v28, v8
    v_add_f32 v23, v27, v28
    v_cos_f32 v128, v27
    v_sin_f32 v144, v27
    v_cos_f32 v129, v23
    v_sin_f32 v145, v23
    v_add_f32 v23, v28, v28
    v_cos_f32 v20, v23
    v_sin_f32 v21, v23
    s_nop 0
    v_pk_mul_f32 v[130:131], v[128:129], v[20:21] op_sel_hi:[1,0]
    v_pk_mul_f32 v[146:147], v[144:145], v[20:21] op_sel_hi:[1,0]
    v_pk_fma_f32 v[130:131], v[144:145], v[20:21], v[130:131] op_sel:[0,1,0] op_sel_hi:[1,1,1] neg_lo:[0,1,0] neg_hi:[0,1,0]
    v_pk_fma_f32 v[146:147], v[128:129], v[20:21], v[146:147] op_sel:[0,1,0] op_sel_hi:[1,1,1]
    v_pk_mul_f32 v[132:133], v[130:131], v[20:21] op_sel_hi:[1,0]
    v_pk_mul_f32 v[148:149], v[146:147], v[20:21] op_sel_hi:[1,0]
    v_pk_fma_f32 v[132:133], v[146:147], v[20:21], v[132:133] op_sel:[0,1,0] op_sel_hi:[1,1,1] neg_lo:[0,1,0] neg_hi:[0,1,0]
    v_pk_fma_f32 v[148:149], v[130:131], v[20:21], v[148:149] op_sel:[0,1,0] op_sel_hi:[1,1,1]
    v_pk_mul_f32 v[134:135], v[132:133], v[20:21] op_sel_hi:[1,0]
    v_pk_mul_f32 v[150:151], v[148:149], v[20:21] op_sel_hi:[1,0]
    v_pk_fma_f32 v[134:135], v[148:149], v[20:21], v[134:135] op_sel:[0,1,0] op_sel_hi:[1,1,1] neg_lo:[0,1,0] neg_hi:[0,1,0]
    v_pk_fma_f32 v[150:151], v[132:133], v[20:21], v[150:151] op_sel:[0,1,0] op_sel_hi:[1,1,1]
    v_pk_mul_f32 v[136:137], v[134:135], v[20:21] op_sel_hi:[1,0]
    v_pk_mul_f32 v[152:153], v[150:151], v[20:21] op_sel_hi:[1,0]
    v_pk_fma_f32 v[136:137], v[150:151], v[20:21], v[136:137] op_sel:[0,1,0] op_sel_hi:[1,1,1] neg_lo:[0,1,0] neg_hi:[0,1,0]
    v_pk_fma_f32 v[152:153], v[134:135], v[20:21], v[152:153] op_sel:[0,1,0] op_sel_hi:[1,1,1]
    v_pk_mul_f32 v[138:139], v[136:137], v[20:21] op_sel_hi:[1,0]
    v_pk_mul_f32 v[154:155], v[152:153], v[20:21] op_sel_hi:[1,0]
    v_pk_fma_f32 v[138:139], v[152:153], v[20:21], v[138:139] op_sel:[0,1,0] op_sel_hi:[1,1,1] neg_lo:[0,1,0] neg_hi:[0,1,0]
    v_pk_fma_f32 v[154:155], v[136:137], v[20:21], v[154:155] op_sel:[0,1,0] op_sel_hi:[1,1,1]
    v_pk_mul_f32 v[140:141], v[138:139], v[20:21] op_sel_hi:[1,0]
    v_pk_mul_f32 v[156:157], v[154:155], v[20:21] op_sel_hi:[1,0]
    v_pk_fma_f32 v[140:141], v[154:155], v[20:21], v[140:141] op_sel:[0,1,0] op_sel_hi:[1,1,1] neg_lo:[0,1,0] neg_hi:[0,1,0]
    v_pk_fma_f32 v[156:157], v[138:139], v[20:21], v[156:157] op_sel:[0,1,0] op_sel_hi:[1,1,1]
    v_pk_mul_f32 v[142:143], v[140:141], v[20:21] op_sel_hi:[1,0]
    v_pk_mul_f32 v[158:159], v[156:157], v[20:21] op_sel_hi:[1,0]
    v_pk_fma_f32 v[142:143], v[156:157], v[20:21], v[142:143] op_sel:[0,1,0] op_sel_hi:[1,1,1] neg_lo:[0,1,0] neg_hi:[0,1,0]
    v_pk_fma_f32 v[158:159], v[140:141], v[20:21], v[158:159] op_sel:[0,1,0] op_sel_hi:[1,1,1]
    v_cvt_pk_bf16_f32 v240, v128, v129
    v_cvt_pk_bf16_f32 v241, v144, v145
    v_cvt_pk_bf16_f32 v242, -v144, -v145
    v_accvgpr_write_b32 a0, v240
    v_accvgpr_write_b32 a8, v241
    v_accvgpr_write_b32 a16, v242
    v_cvt_pk_bf16_f32 v244, v130, v131
    v_cvt_pk_bf16_f32 v245, v146, v147
    v_cvt_pk_bf16_f32 v246, -v146, -v147
    v_accvgpr_write_b32 a1, v244
    v_accvgpr_write_b32 a9, v245
    v_accvgpr_write_b32 a17, v246
    v_cvt_pk_bf16_f32 v240, v132, v133
    v_cvt_pk_bf16_f32 v241, v148, v149
    v_cvt_pk_bf16_f32 v242, -v148, -v149
    v_accvgpr_write_b32 a2, v240
    v_accvgpr_write_b32 a10, v241
    v_accvgpr_write_b32 a18, v242
    v_cvt_pk_bf16_f32 v244, v134, v135
    v_cvt_pk_bf16_f32 v245, v150, v151
    v_cvt_pk_bf16_f32 v246, -v150, -v151
    v_accvgpr_write_b32 a3, v244
    v_accvgpr_write_b32 a11, v245
    v_accvgpr_write_b32 a19, v246
    v_cvt_pk_bf16_f32 v240, v136, v137
    v_cvt_pk_bf16_f32 v241, v152, v153
    v_cvt_pk_bf16_f32 v242, -v152, -v153
    v_accvgpr_write_b32 a4, v240
    v_accvgpr_write_b32 a12, v241
    v_accvgpr_write_b32 a20, v242
    v_cvt_pk_bf16_f32 v244, v138, v139
    v_cvt_pk_bf16_f32 v245, v154, v155
    v_cvt_pk_bf16_f32 v246, -v154, -v155
    v_accvgpr_write_b32 a5, v244
    v_accvgpr_write_b32 a13, v245
    v_accvgpr_write_b32 a21, v246
    v_cvt_pk_bf16_f32 v240, v140, v141
    v_cvt_pk_bf16_f32 v241, v156, v157
    v_cvt_pk_bf16_f32 v242, -v156, -v157
    v_accvgpr_write_b32 a6, v240
    v_accvgpr_write_b32 a14, v241
    v_accvgpr_write_b32 a22, v242
    v_cvt_pk_bf16_f32 v244, v142, v143
    v_cvt_pk_bf16_f32 v245, v158, v159
    v_cvt_pk_bf16_f32 v246, -v158, -v159
    v_accvgpr_write_b32 a7, v244
    v_accvgpr_write_b32 a15, v245
    v_accvgpr_write_b32 a23, v246
    v_mul_f32 v28, 0x3a800000, v4
    v_mul_f32 v27, v28, v8
    v_add_f32 v23, v27, v28
    v_cos_f32 v192, v27
    v_sin_f32 v208, v27
    v_cos_f32 v193, v23
    v_sin_f32 v209, v23
    v_add_f32 v23, v28, v28
    v_cos_f32 v20, v23
    v_sin_f32 v21, v23
    s_nop 0
    v_pk_mul_f32 v[194:195], v[192:193], v[20:21] op_sel_hi:[1,0]
    v_pk_mul_f32 v[210:211], v[208:209], v[20:21] op_sel_hi:[1,0]
    v_pk_fma_f32 v[194:195], v[208:209], v[20:21], v[194:195] op_sel:[0,1,0] op_sel_hi:[1,1,1] neg_lo:[0,1,0] neg_hi:[0,1,0]
    v_pk_fma_f32 v[210:211], v[192:193], v[20:21], v[210:211] op_sel:[0,1,0] op_sel_hi:[1,1,1]
    v_pk_mul_f32 v[196:197], v[194:195], v[20:21] op_sel_hi:[1,0]
    v_pk_mul_f32 v[212:213], v[210:211], v[20:21] op_sel_hi:[1,0]
    v_pk_fma_f32 v[196:197], v[210:211], v[20:21], v[196:197] op_sel:[0,1,0] op_sel_hi:[1,1,1] neg_lo:[0,1,0] neg_hi:[0,1,0]
    v_pk_fma_f32 v[212:213], v[194:195], v[20:21], v[212:213] op_sel:[0,1,0] op_sel_hi:[1,1,1]
    v_pk_mul_f32 v[198:199], v[196:197], v[20:21] op_sel_hi:[1,0]
    v_pk_mul_f32 v[214:215], v[212:213], v[20:21] op_sel_hi:[1,0]
    v_pk_fma_f32 v[198:199], v[212:213], v[20:21], v[198:199] op_sel:[0,1,0] op_sel_hi:[1,1,1] neg_lo:[0,1,0] neg_hi:[0,1,0]
    v_pk_fma_f32 v[214:215], v[196:197], v[20:21], v[214:215] op_sel:[0,1,0] op_sel_hi:[1,1,1]
    v_pk_mul_f32 v[200:201], v[198:199], v[20:21] op_sel_hi:[1,0]
    v_pk_mul_f32 v[216:217], v[214:215], v[20:21] op_sel_hi:[1,0]
    v_pk_fma_f32 v[200:201], v[214:215], v[20:21], v[200:201] op_sel:[0,1,0] op_sel_hi:[1,1,1] neg_lo:[0,1,0] neg_hi:[0,1,0]
    v_pk_fma_f32 v[216:217], v[198:199], v[20:21], v[216:217] op_sel:[0,1,0] op_sel_hi:[1,1,1]
    v_pk_mul_f32 v[202:203], v[200:201], v[20:21] op_sel_hi:[1,0]
    v_pk_mul_f32 v[218:219], v[216:217], v[20:21] op_sel_hi:[1,0]
    v_pk_fma_f32 v[202:203], v[216:217], v[20:21], v[202:203] op_sel:[0,1,0] op_sel_hi:[1,1,1] neg_lo:[0,1,0] neg_hi:[0,1,0]
    v_pk_fma_f32 v[218:219], v[200:201], v[20:21], v[218:219] op_sel:[0,1,0] op_sel_hi:[1,1,1]
    v_pk_mul_f32 v[204:205], v[202:203], v[20:21] op_sel_hi:[1,0]
    v_pk_mul_f32 v[220:221], v[218:219], v[20:21] op_sel_hi:[1,0]
    v_pk_fma_f32 v[204:205], v[218:219], v[20:21], v[204:205] op_sel:[0,1,0] op_sel_hi:[1,1,1] neg_lo:[0,1,0] neg_hi:[0,1,0]
    v_pk_fma_f32 v[220:221], v[202:203], v[20:21], v[220:221] op_sel:[0,1,0] op_sel_hi:[1,1,1]
    v_pk_mul_f32 v[206:207], v[204:205], v[20:21] op_sel_hi:[1,0]
    v_pk_mul_f32 v[222:223], v[220:221], v[20:21] op_sel_hi:[1,0]
    v_pk_fma_f32 v[206:207], v[220:221], v[20:21], v[206:207] op_sel:[0,1,0] op_sel_hi:[1,1,1] neg_lo:[0,1,0] neg_hi:[0,1,0]
    v_pk_fma_f32 v[222:223], v[204:205], v[20:21], v[222:223] op_sel:[0,1,0] op_sel_hi:[1,1,1]
    v_lshrrev_b32 v28, 2, v0
    v_and_b32 v27, 2, v0
    v_cmp_ne_u32 s[48:49], 0, v27
    v_and_b32_e64 v27, 1, v0
    v_cmp_ne_u32 s[52:53], 0, v27
    v_mul_u32_u24 v27, 19488, v27
    v_add_u32 v27, 50176, v27
    v_add_u32 v26, 0, v28
    v_sub_u32 v25, 0x200, v26
    v_cmp_eq_u32 vcc, 0, v26
    v_mov_b32 v24, 0x100
    s_nop 0
    v_cndmask_b32 v25, v25, v24, vcc
    v_cndmask_b32 v26, v26, v25, s[48:49]
    v_sub_u32 v25, 0x400, v26
    v_and_b32 v25, 0x3ff, v25
    v_cndmask_b32 v24, v25, v26, s[52:53]
    v_cndmask_b32 v25, v26, v25, s[52:53]
    v_lshrrev_b32 v23, 5, v24
    v_mul_u32_u24 v64, 144, v23
    v_lshrrev_b32 v23, 9, v24
    v_lshl_add_u32 v64, v23, 6, v64
    v_and_b32 v23, 31, v24
    v_lshl_add_u32 v64, v23, 2, v64
    v_add_u32 v64, v64, v27
    v_lshrrev_b32 v23, 5, v25
    v_mul_u32_u24 v68, 144, v23
    v_lshrrev_b32 v23, 9, v25
    v_lshl_add_u32 v68, v23, 6, v68
    v_and_b32 v23, 31, v25
    v_lshl_add_u32 v68, v23, 2, v68
    v_add_u32 v68, v68, v27
    v_add_u32_e64 v26, 64, v28
    v_sub_u32 v25, 0x200, v26
    v_cndmask_b32 v26, v26, v25, s[48:49]
    v_sub_u32 v25, 0x400, v26
    v_and_b32 v25, 0x3ff, v25
    v_cndmask_b32 v24, v25, v26, s[52:53]
    v_cndmask_b32 v25, v26, v25, s[52:53]
    v_lshrrev_b32 v23, 5, v24
    v_mul_u32_u24 v65, 144, v23
    v_lshrrev_b32 v23, 9, v24
    v_lshl_add_u32 v65, v23, 6, v65
    v_and_b32 v23, 31, v24
    v_lshl_add_u32 v65, v23, 2, v65
    v_add_u32 v65, v65, v27
    v_lshrrev_b32 v23, 5, v25
    v_mul_u32_u24 v69, 144, v23
    v_lshrrev_b32 v23, 9, v25
    v_lshl_add_u32 v69, v23, 6, v69
    v_and_b32 v23, 31, v25
    v_lshl_add_u32 v69, v23, 2, v69
    v_add_u32 v69, v69, v27
    v_add_u32 v26, 128, v28
    v_sub_u32 v25, 0x200, v26
    v_cndmask_b32 v26, v26, v25, s[48:49]
    v_sub_u32 v25, 0x400, v26
    v_and_b32 v25, 0x3ff, v25
    v_cndmask_b32 v24, v25, v26, s[52:53]
    v_cndmask_b32 v25, v26, v25, s[52:53]
    v_lshrrev_b32 v23, 5, v24
    v_mul_u32_u24 v66, 144, v23
    v_lshrrev_b32 v23, 9, v24
    v_lshl_add_u32 v66, v23, 6, v66
    v_and_b32 v23, 31, v24
    v_lshl_add_u32 v66, v23, 2, v66
    v_add_u32 v66, v66, v27
    v_lshrrev_b32 v23, 5, v25
    v_mul_u32_u24 v70, 144, v23
    v_lshrrev_b32 v23, 9, v25
    v_lshl_add_u32 v70, v23, 6, v70
    v_and_b32 v23, 31, v25
    v_lshl_add_u32 v70, v23, 2, v70
    v_add_u32 v70, v70, v27
    v_add_u32 v26, 192, v28
    v_sub_u32 v25, 0x200, v26
    v_cndmask_b32 v26, v26, v25, s[48:49]
    v_sub_u32 v25, 0x400, v26
    v_and_b32 v25, 0x3ff, v25
    v_cndmask_b32 v24, v25, v26, s[52:53]
    v_cndmask_b32 v25, v26, v25, s[52:53]
    v_lshrrev_b32 v23, 5, v24
    v_mul_u32_u24 v67, 144, v23
    v_lshrrev_b32 v23, 9, v24
    v_lshl_add_u32 v67, v23, 6, v67
    v_and_b32 v23, 31, v24
    v_lshl_add_u32 v67, v23, 2, v67
    v_add_u32 v67, v67, v27
    v_lshrrev_b32 v23, 5, v25
    v_mul_u32_u24 v71, 144, v23
    v_lshrrev_b32 v23, 9, v25
    v_lshl_add_u32 v71, v23, 6, v71
    v_and_b32 v23, 31, v25
    v_lshl_add_u32 v71, v23, 2, v71
    v_add_u32 v71, v71, v27
    v_cmp_gt_u32 vcc, 2, v0
    v_sub_u32 v24, 122208, v27
    s_nop 0
    v_cndmask_b32 v68, v68, v24, vcc
    s_mov_b64 s[88:89], vcc
    v_and_b32 v26, 3, v0
    v_lshlrev_b32 v26, 4, v26
    v_lshl_add_u32 v9, v28, 14, v26
    s_and_b32 s41, s2, 1
    s_lshl_b32 s41, s41, 8
    v_add_u32 v26, s41, v0
    v_cmp_gt_u32 vcc, 4, v26
    v_mov_b32 v26, 0x7ffffff0
    s_nop 0
    v_cndmask_b32 v17, v9, v26, vcc
    s_lshl_b32 s41, s36, 12
    v_add_u32 v10, s41, v5
    s_lshl_b32 s41, s38, 10
    s_lshl_b32 s42, s37, 3
    s_add_u32 s41, s41, s42
    v_add_u32 v11, s41, v5
    v_mul_u32_u24 v20, 144, v2
    v_lshrrev_b32 v31, 4, v2
    v_add_u32 v31, v31, v3
    v_lshl_add_u32 v20, v31, 6, v20
    s_mul_i32 s41, s36, 4864
    s_add_u32 s41, s41, 50176
    v_add_u32 v20, s41, v20
    v_mov_b32 v21, v17
    s_waitcnt vmcnt(5)
    s_mov_b32 s41, s92
    s_mov_b32 s42, s93
    v_mov_b32 v28, v18
    v_mov_b32_e64 v29, v19
    buffer_load_dwordx4 v[96:99], v28, s[20:23], s41 offen
    buffer_load_dwordx4 v[100:103], v28, s[20:23], s42 offen
    buffer_load_dword v112, v29, s[20:23], s41 offen offset:512
    buffer_load_dwordx4 v[104:107], v28, s[24:27], s41 offen
    buffer_load_dwordx4 v[108:111], v28, s[24:27], s42 offen
    buffer_load_dword v113, v29, s[24:27], s41 offen offset:512
    v_mfma_f32_32x32x16_bf16 v[160:175], a[80:83], a[72:75], 0
    v_mfma_f32_32x32x16_bf16 v[176:191], a[88:91], a[72:75], 0
    v_mfma_f32_32x32x16_bf16 v[160:175], a[84:87], a[76:79], v[160:175]
    v_mfma_f32_32x32x16_bf16 v[176:191], a[92:95], a[76:79], v[176:191]
    s_nop 10
    v_readlane_b32 s52, v160, 0
    v_readlane_b32 s54, v176, 0
    s_nop 0
    v_pk_add_f32 v[160:161], v[160:161], s[52:53] op_sel_hi:[1,0] neg_lo:[0,1] neg_hi:[0,1]
    v_pk_add_f32 v[176:177], v[176:177], s[54:55] op_sel_hi:[1,0] neg_lo:[0,1] neg_hi:[0,1]
    v_pk_add_f32 v[162:163], v[162:163], s[52:53] op_sel_hi:[1,0] neg_lo:[0,1] neg_hi:[0,1]
    v_pk_add_f32 v[178:179], v[178:179], s[54:55] op_sel_hi:[1,0] neg_lo:[0,1] neg_hi:[0,1]
    v_pk_add_f32 v[164:165], v[164:165], s[52:53] op_sel_hi:[1,0] neg_lo:[0,1] neg_hi:[0,1]
    v_pk_add_f32 v[180:181], v[180:181], s[54:55] op_sel_hi:[1,0] neg_lo:[0,1] neg_hi:[0,1]
    v_pk_add_f32 v[166:167], v[166:167], s[52:53] op_sel_hi:[1,0] neg_lo:[0,1] neg_hi:[0,1]
    v_pk_add_f32 v[182:183], v[182:183], s[54:55] op_sel_hi:[1,0] neg_lo:[0,1] neg_hi:[0,1]
    v_pk_add_f32 v[168:169], v[168:169], s[52:53] op_sel_hi:[1,0] neg_lo:[0,1] neg_hi:[0,1]
    v_pk_add_f32 v[184:185], v[184:185], s[54:55] op_sel_hi:[1,0] neg_lo:[0,1] neg_hi:[0,1]
    v_pk_add_f32 v[170:171], v[170:171], s[52:53] op_sel_hi:[1,0] neg_lo:[0,1] neg_hi:[0,1]
    v_pk_add_f32 v[186:187], v[186:187], s[54:55] op_sel_hi:[1,0] neg_lo:[0,1] neg_hi:[0,1]
    v_pk_add_f32 v[172:173], v[172:173], s[52:53] op_sel_hi:[1,0] neg_lo:[0,1] neg_hi:[0,1]
    v_pk_add_f32 v[188:189], v[188:189], s[54:55] op_sel_hi:[1,0] neg_lo:[0,1] neg_hi:[0,1]
    v_pk_add_f32 v[174:175], v[174:175], s[52:53] op_sel_hi:[1,0] neg_lo:[0,1] neg_hi:[0,1]
    v_pk_add_f32 v[190:191], v[190:191], s[54:55] op_sel_hi:[1,0] neg_lo:[0,1] neg_hi:[0,1]
    v_pk_add_f32 v[240:241], v[160:161], v[162:163]
    v_pk_mul_f32 v[244:245], v[160:161], v[160:161]
    v_pk_add_f32 v[242:243], v[176:177], v[178:179]
    v_pk_mul_f32 v[246:247], v[176:177], v[176:177]
    v_pk_fma_f32 v[244:245], v[162:163], v[162:163], v[244:245]
    v_pk_fma_f32 v[246:247], v[178:179], v[178:179], v[246:247]
    v_pk_add_f32 v[240:241], v[240:241], v[164:165]
    v_pk_fma_f32 v[244:245], v[164:165], v[164:165], v[244:245]
    v_pk_add_f32 v[242:243], v[242:243], v[180:181]
    v_pk_fma_f32 v[246:247], v[180:181], v[180:181], v[246:247]
    v_pk_add_f32 v[240:241], v[240:241], v[166:167]
    v_pk_fma_f32 v[244:245], v[166:167], v[166:167], v[244:245]
    v_pk_add_f32 v[242:243], v[242:243], v[182:183]
    v_pk_fma_f32 v[246:247], v[182:183], v[182:183], v[246:247]
    v_pk_add_f32 v[240:241], v[240:241], v[168:169]
    v_pk_fma_f32 v[244:245], v[168:169], v[168:169], v[244:245]
    v_pk_add_f32 v[242:243], v[242:243], v[184:185]
    v_pk_fma_f32 v[246:247], v[184:185], v[184:185], v[246:247]
    v_pk_add_f32 v[240:241], v[240:241], v[170:171]
    v_pk_fma_f32 v[244:245], v[170:171], v[170:171], v[244:245]
    v_pk_add_f32 v[242:243], v[242:243], v[186:187]
    v_pk_fma_f32 v[246:247], v[186:187], v[186:187], v[246:247]
    v_pk_add_f32 v[240:241], v[240:241], v[172:173]
    v_pk_fma_f32 v[244:245], v[172:173], v[172:173], v[244:245]
    v_pk_add_f32 v[242:243], v[242:243], v[188:189]
    v_pk_fma_f32 v[246:247], v[188:189], v[188:189], v[246:247]
    v_pk_add_f32 v[240:241], v[240:241], v[174:175]
    v_pk_fma_f32 v[244:245], v[174:175], v[174:175], v[244:245]
    v_pk_add_f32 v[242:243], v[242:243], v[190:191]
    v_pk_fma_f32 v[246:247], v[190:191], v[190:191], v[246:247]
    v_add_f32 v240, v240, v241
    v_add_f32 v242, v242, v243
    v_add_f32 v244, v244, v245
    v_add_f32 v246, v246, v247
    v_permlane32_swap_b32 v240, v242
    s_nop 0
    v_permlane32_swap_b32 v244, v246
    v_add_f32 v240, v240, v242
    v_add_f32 v244, v244, v246
    v_mov_b32 v242, v240
    v_mov_b32 v246, v244
    s_nop 0
    v_permlane16_swap_b32 v240, v242
    v_permlane16_swap_b32 v244, v246
    v_add_f32 v240, v240, v242
    v_add_f32 v244, v244, v246
    v_mov_b32_e64 v248, s52
    v_add_f32_dpp v240, v240, v240 row_ror:8 row_mask:0xf bank_mask:0xf
    v_add_f32_dpp v244, v244, v244 row_ror:8 row_mask:0xf bank_mask:0xf
    v_mov_b32_e64 v249, s54
    v_add_f32_dpp v240, v240, v240 row_ror:4 row_mask:0xf bank_mask:0xf
    v_add_f32_dpp v244, v244, v244 row_ror:4 row_mask:0xf bank_mask:0xf
    v_cmp_eq_u32 vcc, 0, v3
    v_add_f32_dpp v240, v240, v240 row_ror:2 row_mask:0xf bank_mask:0xf
    v_add_f32_dpp v244, v244, v244 row_ror:2 row_mask:0xf bank_mask:0xf
    s_lshl_b32 s41, s36, 2
    v_add_f32_dpp v240, v240, v240 row_ror:1 row_mask:0xf bank_mask:0xf
    v_add_f32_dpp v244, v244, v244 row_ror:1 row_mask:0xf bank_mask:0xf
    v_cndmask_b32 v248, v249, v248, vcc
    v_mul_f32 v240, 0x3a800000, v240
    v_mul_f32 v244, 0x3a800000, v244
    v_fma_f32 v244, -v240, v240, v244
    v_add_f32 v249, v248, v240
    v_mov_b32 v251, v244
    v_max_f32 v244, 0, v244
    v_cvt_pk_bf16_f32 v244, v244, v244
    v_and_b32 v244, 0xffff0000, v244
    v_add_f32 v244, 0x3727c5ac, v244
    v_cvt_pk_bf16_f32 v244, v244, v244
    v_and_b32 v244, 0xffff0000, v244
    v_sqrt_f32 v244, v244
    s_nop 0
    v_cvt_pk_bf16_f32 v244, v244, v244
    v_and_b32 v244, 0xffff0000, v244
    v_cvt_pk_bf16_f32 v250, v249, v249
    v_and_b32 v250, 0xffff0000, v250
    v_rcp_f32 v242, v244
    v_sub_f32 v250, v248, v250
    v_mul_f32 v242, 0.5, v242
    v_mul_f32 v250, v250, v242
    v_mul_f32 v249, 0x44800000, v249
    v_readlane_b32 s52, v242, 0
    v_readlane_b32 s53, v250, 0
    v_readlane_b32 s54, v242, 32
    v_readlane_b32 s55, v250, 32
    s_add_u32 s41, s41, 49152
    v_lshlrev_b32 v30, 4, v3
    v_add_u32 v30, s41, v30
    v_mul_f32_e64 v244, 0.5, v244
    ds_write2_b32 v30, v244, v249 offset0:0 offset1:8
    ds_write_b32 v30, v251 offset:64
    v_pk_fma_f32 v[160:161], v[160:161], s[52:53], s[52:53] op_sel:[0,0,1] op_sel_hi:[1,0,1]
    v_pk_fma_f32 v[176:177], v[176:177], s[54:55], s[54:55] op_sel:[0,0,1] op_sel_hi:[1,0,1]
    v_pk_add_f32 v[240:241], v[160:161], v[176:177]
    v_pk_add_f32 v[242:243], v[160:161], v[176:177] neg_lo:[0,1] neg_hi:[0,1]
    v_cvt_pk_bf16_f32 v224, v240, v241
    v_cvt_pk_bf16_f32 v232, v242, v243
    v_pk_fma_f32 v[162:163], v[162:163], s[52:53], s[52:53] op_sel:[0,0,1] op_sel_hi:[1,0,1]
    v_pk_fma_f32 v[178:179], v[178:179], s[54:55], s[54:55] op_sel:[0,0,1] op_sel_hi:[1,0,1]
    v_pk_add_f32 v[244:245], v[162:163], v[178:179]
    v_pk_add_f32 v[246:247], v[162:163], v[178:179] neg_lo:[0,1] neg_hi:[0,1]
    v_cvt_pk_bf16_f32 v225, v244, v245
    v_cvt_pk_bf16_f32 v233, v246, v247
    v_pk_fma_f32 v[164:165], v[164:165], s[52:53], s[52:53] op_sel:[0,0,1] op_sel_hi:[1,0,1]
    v_pk_fma_f32 v[180:181], v[180:181], s[54:55], s[54:55] op_sel:[0,0,1] op_sel_hi:[1,0,1]
    v_pk_add_f32 v[240:241], v[164:165], v[180:181]
    v_pk_add_f32 v[242:243], v[164:165], v[180:181] neg_lo:[0,1] neg_hi:[0,1]
    v_cvt_pk_bf16_f32 v226, v240, v241
    v_cvt_pk_bf16_f32 v234, v242, v243
    v_pk_fma_f32 v[166:167], v[166:167], s[52:53], s[52:53] op_sel:[0,0,1] op_sel_hi:[1,0,1]
    v_pk_fma_f32 v[182:183], v[182:183], s[54:55], s[54:55] op_sel:[0,0,1] op_sel_hi:[1,0,1]
    v_pk_add_f32 v[244:245], v[166:167], v[182:183]
    v_pk_add_f32 v[246:247], v[166:167], v[182:183] neg_lo:[0,1] neg_hi:[0,1]
    v_cvt_pk_bf16_f32 v227, v244, v245
    v_cvt_pk_bf16_f32 v235, v246, v247
    v_pk_fma_f32 v[168:169], v[168:169], s[52:53], s[52:53] op_sel:[0,0,1] op_sel_hi:[1,0,1]
    v_pk_fma_f32 v[184:185], v[184:185], s[54:55], s[54:55] op_sel:[0,0,1] op_sel_hi:[1,0,1]
    v_pk_add_f32 v[240:241], v[168:169], v[184:185]
    v_pk_add_f32 v[242:243], v[168:169], v[184:185] neg_lo:[0,1] neg_hi:[0,1]
    v_cvt_pk_bf16_f32 v228, v240, v241
    v_cvt_pk_bf16_f32 v236, v242, v243
    v_pk_fma_f32 v[170:171], v[170:171], s[52:53], s[52:53] op_sel:[0,0,1] op_sel_hi:[1,0,1]
    v_pk_fma_f32 v[186:187], v[186:187], s[54:55], s[54:55] op_sel:[0,0,1] op_sel_hi:[1,0,1]
    v_pk_add_f32 v[244:245], v[170:171], v[186:187]
    v_pk_add_f32 v[246:247], v[170:171], v[186:187] neg_lo:[0,1] neg_hi:[0,1]
    v_cvt_pk_bf16_f32 v229, v244, v245
    v_cvt_pk_bf16_f32 v237, v246, v247
    v_pk_fma_f32 v[172:173], v[172:173], s[52:53], s[52:53] op_sel:[0,0,1] op_sel_hi:[1,0,1]
    v_pk_fma_f32 v[188:189], v[188:189], s[54:55], s[54:55] op_sel:[0,0,1] op_sel_hi:[1,0,1]
    v_pk_add_f32 v[240:241], v[172:173], v[188:189]
    v_pk_add_f32 v[242:243], v[172:173], v[188:189] neg_lo:[0,1] neg_hi:[0,1]
    v_cvt_pk_bf16_f32 v230, v240, v241
    v_cvt_pk_bf16_f32 v238, v242, v243
    v_pk_fma_f32 v[174:175], v[174:175], s[52:53], s[52:53] op_sel:[0,0,1] op_sel_hi:[1,0,1]
    v_pk_fma_f32 v[190:191], v[190:191], s[54:55], s[54:55] op_sel:[0,0,1] op_sel_hi:[1,0,1]
    v_pk_add_f32 v[244:245], v[174:175], v[190:191]
    v_pk_add_f32 v[246:247], v[174:175], v[190:191] neg_lo:[0,1] neg_hi:[0,1]
    v_cvt_pk_bf16_f32 v231, v244, v245
    v_cvt_pk_bf16_f32 v239, v246, v247
    v_mfma_f32_32x32x16_bf16 v[128:143], v[224:227], a[0:3], 0
    v_mfma_f32_32x32x16_bf16 v[144:159], v[232:235], a[0:3], 0
    v_mfma_f32_32x32x16_bf16 v[128:143], v[232:235], a[8:11], v[128:143]
    v_mfma_f32_32x32x16_bf16 v[144:159], v[224:227], a[16:19], v[144:159]
    v_mfma_f32_32x32x16_bf16 v[128:143], v[228:231], a[4:7], v[128:143]
    v_mfma_f32_32x32x16_bf16 v[144:159], v[236:239], a[4:7], v[144:159]
    v_mfma_f32_32x32x16_bf16 v[128:143], v[236:239], a[12:15], v[128:143]
    v_mfma_f32_32x32x16_bf16 v[144:159], v[228:231], a[20:23], v[144:159]
    s_nop 10
    s_nop 0
    v_pk_mul_f32 v[240:241], v[128:129], v[192:193]
    v_pk_mul_f32 v[242:243], v[144:145], v[192:193]
    v_pk_fma_f32 v[240:241], v[144:145], v[208:209], v[240:241]
    v_pk_fma_f32 v[242:243], v[128:129], v[208:209], v[242:243] neg_lo:[0,1,0] neg_hi:[0,1,0]
    v_cvt_pk_bf16_f32 v224, v240, v241
    v_cvt_pk_bf16_f32 v232, v242, v243
    v_pk_mul_f32 v[244:245], v[130:131], v[194:195]
    v_pk_mul_f32 v[246:247], v[146:147], v[194:195]
    v_pk_fma_f32 v[244:245], v[146:147], v[210:211], v[244:245]
    v_pk_fma_f32 v[246:247], v[130:131], v[210:211], v[246:247] neg_lo:[0,1,0] neg_hi:[0,1,0]
    v_cvt_pk_bf16_f32 v225, v244, v245
    v_cvt_pk_bf16_f32 v233, v246, v247
    v_pk_mul_f32 v[240:241], v[132:133], v[196:197]
    v_pk_mul_f32 v[242:243], v[148:149], v[196:197]
    v_pk_fma_f32 v[240:241], v[148:149], v[212:213], v[240:241]
    v_pk_fma_f32 v[242:243], v[132:133], v[212:213], v[242:243] neg_lo:[0,1,0] neg_hi:[0,1,0]
    v_cvt_pk_bf16_f32 v226, v240, v241
    v_cvt_pk_bf16_f32 v234, v242, v243
    v_pk_mul_f32 v[244:245], v[134:135], v[198:199]
    v_pk_mul_f32 v[246:247], v[150:151], v[198:199]
    v_pk_fma_f32 v[244:245], v[150:151], v[214:215], v[244:245]
    v_pk_fma_f32 v[246:247], v[134:135], v[214:215], v[246:247] neg_lo:[0,1,0] neg_hi:[0,1,0]
    v_cvt_pk_bf16_f32 v227, v244, v245
    v_cvt_pk_bf16_f32 v235, v246, v247
    v_pk_mul_f32 v[240:241], v[136:137], v[200:201]
    v_pk_mul_f32 v[242:243], v[152:153], v[200:201]
    v_pk_fma_f32 v[240:241], v[152:153], v[216:217], v[240:241]
    v_pk_fma_f32 v[242:243], v[136:137], v[216:217], v[242:243] neg_lo:[0,1,0] neg_hi:[0,1,0]
    v_cvt_pk_bf16_f32 v228, v240, v241
    v_cvt_pk_bf16_f32 v236, v242, v243
    v_pk_mul_f32 v[244:245], v[138:139], v[202:203]
    v_pk_mul_f32 v[246:247], v[154:155], v[202:203]
    v_pk_fma_f32 v[244:245], v[154:155], v[218:219], v[244:245]
    v_pk_fma_f32 v[246:247], v[138:139], v[218:219], v[246:247] neg_lo:[0,1,0] neg_hi:[0,1,0]
    v_cvt_pk_bf16_f32 v229, v244, v245
    v_cvt_pk_bf16_f32 v237, v246, v247
    v_pk_mul_f32 v[240:241], v[140:141], v[204:205]
    v_pk_mul_f32 v[242:243], v[156:157], v[204:205]
    v_pk_fma_f32 v[240:241], v[156:157], v[220:221], v[240:241]
    v_pk_fma_f32 v[242:243], v[140:141], v[220:221], v[242:243] neg_lo:[0,1,0] neg_hi:[0,1,0]
    v_cvt_pk_bf16_f32 v230, v240, v241
    v_cvt_pk_bf16_f32 v238, v242, v243
    v_pk_mul_f32 v[244:245], v[142:143], v[206:207]
    v_pk_mul_f32 v[246:247], v[158:159], v[206:207]
    v_pk_fma_f32 v[244:245], v[158:159], v[222:223], v[244:245]
    v_pk_fma_f32 v[246:247], v[142:143], v[222:223], v[246:247] neg_lo:[0,1,0] neg_hi:[0,1,0]
    v_cvt_pk_bf16_f32 v231, v244, v245
    v_cvt_pk_bf16_f32 v239, v246, v247
    s_waitcnt lgkmcnt(0)
    s_add_u32 s95, s95, 1
    v_mfma_f32_32x32x16_bf16 v[160:175], v[224:227], a[0:3], 0
    v_mfma_f32_32x32x16_bf16 v[160:175], v[232:235], a[8:11], v[160:175]
    v_mfma_f32_32x32x16_bf16 v[160:175], v[228:231], a[4:7], v[160:175]
    v_mfma_f32_32x32x16_bf16 v[160:175], v[236:239], a[12:15], v[160:175]
    v_mfma_f32_32x32x16_bf16 v[176:191], v[232:235], a[0:3], 0
    v_mfma_f32_32x32x16_bf16 v[176:191], v[224:227], a[16:19], v[176:191]
    v_mfma_f32_32x32x16_bf16 v[176:191], v[236:239], a[4:7], v[176:191]
    s_nop 8
    s_nop 0
    ds_write_b128 v20, v[160:163] offset:0
    ds_write_b128 v20, v[164:167] offset:16
    ds_write_b128 v20, v[168:171] offset:32
    ds_write_b128 v20, v[172:175] offset:48
    v_mfma_f32_32x32x16_bf16 v[176:191], v[228:231], a[20:23], v[176:191]
    s_nop 11
    s_nop 0
    ds_write_b128 v20, v[176:179] offset:19488
    ds_write_b128 v20, v[180:183] offset:19504
    ds_write_b128 v20, v[184:187] offset:19520
    ds_write_b128 v20, v[188:191] offset:19536
    s_lshl_b32 s43, s2, 6
    s_add_u32 s43, s43, 16777216
    s_waitcnt lgkmcnt(0)
    s_barrier
    s_nop 0
    ds_read2st64_b32 v[128:129], v64 offset0:0 offset1:19
    ds_read2st64_b32 v[130:131], v64 offset0:38 offset1:57
    ds_read2st64_b32 v[132:133], v68 offset0:0 offset1:19
    ds_read2st64_b32 v[134:135], v68 offset0:38 offset1:57
    ds_read2st64_b32 v[136:137], v65 offset0:0 offset1:19
    ds_read2st64_b32 v[138:139], v65 offset0:38 offset1:57
    ds_read2st64_b32 v[140:141], v69 offset0:0 offset1:19
    ds_read2st64_b32 v[142:143], v69 offset0:38 offset1:57
    ds_read2st64_b32 v[144:145], v66 offset0:0 offset1:19
    ds_read2st64_b32 v[146:147], v66 offset0:38 offset1:57
    ds_read2st64_b32 v[148:149], v70 offset0:0 offset1:19
    ds_read2st64_b32 v[150:151], v70 offset0:38 offset1:57
    ds_read2st64_b32 v[152:153], v67 offset0:0 offset1:19
    ds_read2st64_b32 v[154:155], v67 offset0:38 offset1:57
    ds_read2st64_b32 v[156:157], v71 offset0:0 offset1:19
    ds_read2st64_b32 v[158:159], v71 offset0:38 offset1:57
    s_waitcnt lgkmcnt(12)
    s_nop 0
    v_pk_add_f32 v[240:241], v[128:129], v[132:133]
    v_pk_add_f32 v[244:245], v[128:129], v[132:133] neg_lo:[0,1] neg_hi:[0,1]
    v_pk_add_f32 v[242:243], v[130:131], v[134:135]
    v_pk_add_f32 v[246:247], v[130:131], v[134:135] neg_lo:[0,1] neg_hi:[0,1]
    s_mov_b64 exec, s[88:89]
    s_nop 0
    v_pk_add_f32 v[240:241], v[128:129], v[128:129]
    v_pk_add_f32 v[244:245], v[132:133], v[132:133]
    v_pk_add_f32 v[242:243], v[130:131], v[130:131]
    v_pk_add_f32 v[246:247], v[134:135], v[134:135]
    s_mov_b64 exec, -1
    s_nop 0
    v_cvt_pk_bf16_f32 v224, v240, v241
    v_cvt_pk_bf16_f32 v225, v242, v243
    v_cvt_pk_bf16_f32 v226, v244, v245
    v_cvt_pk_bf16_f32 v227, v246, v247
    s_add_u32 s47, s43, 0
    buffer_store_dwordx4 v[224:227], v9, s[12:15], s47 offen sc1
    s_waitcnt lgkmcnt(8)
    v_pk_add_f32 v[240:241], v[136:137], v[140:141]
    v_pk_add_f32 v[244:245], v[136:137], v[140:141] neg_lo:[0,1] neg_hi:[0,1]
    v_pk_add_f32 v[242:243], v[138:139], v[142:143]
    v_pk_add_f32 v[246:247], v[138:139], v[142:143] neg_lo:[0,1] neg_hi:[0,1]
    v_cvt_pk_bf16_f32 v228, v240, v241
    v_cvt_pk_bf16_f32 v229, v242, v243
    v_cvt_pk_bf16_f32 v230, v244, v245
    v_cvt_pk_bf16_f32 v231, v246, v247
    s_add_u32 s47, s43, 1048576
    buffer_store_dwordx4 v[228:231], v9, s[12:15], s47 offen sc1
    s_waitcnt lgkmcnt(4)
    s_nop 0
    v_pk_add_f32 v[240:241], v[144:145], v[148:149]
    v_pk_add_f32 v[244:245], v[144:145], v[148:149] neg_lo:[0,1] neg_hi:[0,1]
    v_pk_add_f32 v[242:243], v[146:147], v[150:151]
    v_pk_add_f32 v[246:247], v[146:147], v[150:151] neg_lo:[0,1] neg_hi:[0,1]
    v_cvt_pk_bf16_f32 v232, v240, v241
    v_cvt_pk_bf16_f32 v233, v242, v243
    v_cvt_pk_bf16_f32 v234, v244, v245
    v_cvt_pk_bf16_f32 v235, v246, v247
    s_add_u32 s47, s43, 2097152
    buffer_store_dwordx4 v[232:235], v9, s[12:15], s47 offen sc1
    s_waitcnt lgkmcnt(0)
    s_nop 0
    v_pk_add_f32 v[240:241], v[152:153], v[156:157]
    v_pk_add_f32 v[244:245], v[152:153], v[156:157] neg_lo:[0,1] neg_hi:[0,1]
    v_pk_add_f32 v[242:243], v[154:155], v[158:159]
    v_pk_add_f32 v[246:247], v[154:155], v[158:159] neg_lo:[0,1] neg_hi:[0,1]
    v_cvt_pk_bf16_f32 v236, v240, v241
    v_cvt_pk_bf16_f32 v237, v242, v243
    v_cvt_pk_bf16_f32 v238, v244, v245
    v_cvt_pk_bf16_f32 v239, v246, v247
    s_add_u32 s47, s43, 3145728
    buffer_store_dwordx4 v[236:239], v9, s[12:15], s47 offen sc1
    s_cmp_lg_u32 s36, 0
    s_cbranch_scc1 L_st_1
    v_add_u32 v30, 49152, v6
    ds_read_b128 v[248:251], v30
    s_and_b32 s42, s2, 3
    s_lshr_b32 s43, s2, 4
    s_and_b32 s43, s43, 1
    s_lshl_b32 s43, s43, 2
    s_or_b32 s42, s42, s43
    s_lshr_b32 s43, s2, 2
    s_and_b32 s43, s43, 3
    s_lshl_b32 s43, s43, 3
    s_or_b32 s42, s42, s43
    s_lshr_b32 s43, s2, 7
    s_lshl_b32 s43, s43, 5
    s_add_u32 s42, s42, s43
    s_lshl_b32 s42, s42, 4
    s_lshr_b32 s43, s2, 5
    s_and_b32 s43, s43, 3
    s_lshl_b32 s43, s43, 10
    s_add_u32 s42, s42, s43
    s_add_u32 s42, s42, 262144
    v_lshlrev_b32 v30, 12, v0
    s_waitcnt lgkmcnt(0)
    s_mov_b64 exec, 63
    buffer_store_dwordx4 v[248:251], v30, s[12:15], s42 offen sc1
    s_mov_b64 exec, -1
L_st_1:
    s_waitcnt vmcnt(4)
    s_mul_i32 s41, s36, 2112
    s_add_u32 s41, s41, 89344
    v_and_b32 v30, 31, v1
    v_lshlrev_b32 v30, 4, v30
    v_mul_u32_u24 v31, 528, v3
    v_add3_u32 v30, v30, v31, s41
    v_and_b32 v31, 3, v1
    v_mul_u32_u24 v31, 528, v31
    v_add_u32 v31, s41, v31
    ds_write_b128 v30, v[96:99] offset:0
    ds_write_b128 v30, v[100:103] offset:1056
    ds_write_b32 v31, v112 offset:512
    ds_write_b128 v30, v[104:107] offset:8448
    ds_write_b128 v30, v[108:111] offset:9504
    ds_write_b32 v31, v113 offset:8960
    s_waitcnt lgkmcnt(0)
    s_barrier
    s_cmp_lg_u32 s36, 0
    s_cbranch_scc1 L_wsp_2
    s_and_b32 s41, s2, 1
    s_lshl_b32 s42, s41, 9
    s_and_b32 s43, s2, 2
    s_add_u32 s42, s42, s43
    s_add_u32 s42, s42, 89344
    v_and_b32 v30, 3, v1
    v_lshlrev_b32 v30, 2, v30
    v_bfe_u32 v31, v1, 2, 2
    v_add_u32 v30, v30, v31
    v_mul_u32_u24 v30, 528, v30
    v_add_u32 v30, s42, v30
    ds_read_u16 v24, v30
    ds_read_u16 v25, v30 offset:8448
    v_accvgpr_read_b32 v26, a246
    v_accvgpr_read_b32 v27, a247
    s_mul_i32 s41, s41, 4186112
    s_add_u32 s41, s41, s57
    s_add_u32 s41, s41, 25165824
    v_lshlrev_b32 v26, 16, v26
    v_lshlrev_b32 v27, 16, v27
    v_lshlrev_b32 v30, 2, v1
    s_waitcnt lgkmcnt(0)
    v_lshlrev_b32 v24, 16, v24
    v_lshlrev_b32 v25, 16, v25
    v_add_f32 v24, v24, v26
    v_sub_f32_e64 v25, v25, v27
    v_mul_f32 v24, 0x3e800000, v24
    v_mul_f32 v25, 0x3e800000, v25
    v_cvt_pk_bf16_f32 v24, v24, v25
    s_mov_b64 exec, 0xffff
    buffer_store_dword v24, v30, s[12:15], s41 offen sc1
    s_mov_b64 exec, -1
L_wsp_2:
    v_lshrrev_b32 v28, 2, v0
    v_and_b32 v29, 3, v0
    v_mul_u32_u24 v29, 528, v29
    s_and_b32 s48, s2, 2
    s_add_u32 s48, s48, 89344
    v_add_u32 v29, s48, v29
    s_and_b32 s49, s2, 1
    s_sub_u32 s49, 0, s49
    v_add_u32 v30, 0, v28
    v_xor_b32 v30, s49, v30
    v_subrev_u32 v30, s49, v30
    v_and_b32 v30, 0xff, v30
    v_lshl_add_u32 v30, v30, 1, v29
    ds_read_u16 v176, v30 offset:0
    ds_read_u16 v160, v30 offset:8448
    ds_read_u16 v177, v30 offset:2112
    ds_read_u16 v161, v30 offset:10560
    ds_read_u16 v178, v30 offset:4224
    ds_read_u16 v162, v30 offset:12672
    ds_read_u16 v179, v30 offset:6336
    ds_read_u16 v163, v30 offset:14784
    v_add_u32 v30, 64, v28
    v_xor_b32 v30, s49, v30
    v_subrev_u32_e64 v30, s49, v30
    v_and_b32 v30, 0xff, v30
    v_lshl_add_u32 v30, v30, 1, v29
    ds_read_u16 v180, v30 offset:0
    ds_read_u16 v164, v30 offset:8448
    ds_read_u16 v181, v30 offset:2112
    ds_read_u16 v165, v30 offset:10560
    ds_read_u16 v182, v30 offset:4224
    ds_read_u16 v166, v30 offset:12672
    ds_read_u16 v183, v30 offset:6336
    ds_read_u16 v167, v30 offset:14784
    v_add_u32 v30, 128, v28
    v_xor_b32 v30, s49, v30
    v_subrev_u32 v30, s49, v30
    v_and_b32 v30, 0xff, v30
    v_lshl_add_u32 v30, v30, 1, v29
    ds_read_u16 v184, v30 offset:0
    ds_read_u16 v168, v30 offset:8448
    ds_read_u16 v185, v30 offset:2112
    ds_read_u16 v169, v30 offset:10560
    ds_read_u16 v186, v30 offset:4224
    ds_read_u16 v170, v30 offset:12672
    ds_read_u16 v187, v30 offset:6336
    ds_read_u16 v171, v30 offset:14784
    v_add_u32 v30, 192, v28
    v_xor_b32 v30, s49, v30
    v_subrev_u32 v30, s49, v30
    v_and_b32 v30, 0xff, v30
    v_lshl_add_u32 v30, v30, 1, v29
    ds_read_u16 v188, v30 offset:0
    ds_read_u16 v172, v30 offset:8448
    ds_read_u16 v189, v30 offset:2112
    ds_read_u16 v173, v30 offset:10560
    ds_read_u16 v190, v30 offset:4224
    ds_read_u16 v174, v30 offset:12672
    ds_read_u16 v191, v30 offset:6336
    ds_read_u16 v175, v30 offset:14784
    s_add_u32 s48, s57, 25165824
    s_waitcnt lgkmcnt(15)
    s_nop 0
    v_lshl_or_b32 v176, v160, 16, v176
    v_lshl_or_b32 v177, v161, 16, v177
    v_lshl_or_b32 v178, v162, 16, v178
    v_lshl_or_b32 v179, v163, 16, v179
    s_add_u32 s49, s48, 0
    buffer_store_dwordx4 v[176:179], v21, s[12:15], s49 offen sc1
    s_waitcnt lgkmcnt(15)
    v_lshl_or_b32 v180, v164, 16, v180
    v_lshl_or_b32 v181, v165, 16, v181
    v_lshl_or_b32 v182, v166, 16, v182
    v_lshl_or_b32 v183, v167, 16, v183
    s_add_u32 s49, s48, 1048576
    buffer_store_dwordx4 v[180:183], v9, s[12:15], s49 offen sc1
    s_waitcnt lgkmcnt(8)
    s_nop 0
    v_lshl_or_b32 v184, v168, 16, v184
    v_lshl_or_b32 v185, v169, 16, v185
    v_lshl_or_b32 v186, v170, 16, v186
    v_lshl_or_b32 v187, v171, 16, v187
    s_add_u32 s49, s48, 2097152
    buffer_store_dwordx4 v[184:187], v9, s[12:15], s49 offen sc1
    s_waitcnt lgkmcnt(0)
    s_nop 0
    v_lshl_or_b32 v188, v172, 16, v188
    v_lshl_or_b32 v189, v173, 16, v189
    v_lshl_or_b32 v190, v174, 16, v190
    v_lshl_or_b32 v191, v175, 16, v191
    s_add_u32 s49, s48, 3145728
    buffer_store_dwordx4 v[188:191], v9, s[12:15], s49 offen sc1
    v_cvt_f32_u32_e64 v26, s37
    v_fma_f32 v25, 2.0, v4, v26
    v_mul_f32 v28, 0x3c800000, v25
    v_mul_f32 v27, v28, v8
    v_add_f32 v23, v27, v28
    v_cos_f32 v128, v27
    v_sin_f32 v144, v27
    v_cos_f32 v129, v23
    v_sin_f32 v145, v23
    v_add_f32 v23, v28, v28
    v_cos_f32 v20, v23
    v_sin_f32 v21, v23
    s_nop 0
    v_pk_mul_f32 v[130:131], v[128:129], v[20:21] op_sel_hi:[1,0]
    v_pk_mul_f32 v[146:147], v[144:145], v[20:21] op_sel_hi:[1,0]
    v_pk_fma_f32 v[130:131], v[144:145], v[20:21], v[130:131] op_sel:[0,1,0] op_sel_hi:[1,1,1] neg_lo:[0,1,0] neg_hi:[0,1,0]
    v_pk_fma_f32 v[146:147], v[128:129], v[20:21], v[146:147] op_sel:[0,1,0] op_sel_hi:[1,1,1]
    v_pk_mul_f32 v[132:133], v[130:131], v[20:21] op_sel_hi:[1,0]
    v_pk_mul_f32 v[148:149], v[146:147], v[20:21] op_sel_hi:[1,0]
    v_pk_fma_f32 v[132:133], v[146:147], v[20:21], v[132:133] op_sel:[0,1,0] op_sel_hi:[1,1,1] neg_lo:[0,1,0] neg_hi:[0,1,0]
    v_pk_fma_f32 v[148:149], v[130:131], v[20:21], v[148:149] op_sel:[0,1,0] op_sel_hi:[1,1,1]
    v_pk_mul_f32 v[134:135], v[132:133], v[20:21] op_sel_hi:[1,0]
    v_pk_mul_f32 v[150:151], v[148:149], v[20:21] op_sel_hi:[1,0]
    v_pk_fma_f32 v[134:135], v[148:149], v[20:21], v[134:135] op_sel:[0,1,0] op_sel_hi:[1,1,1] neg_lo:[0,1,0] neg_hi:[0,1,0]
    v_pk_fma_f32 v[150:151], v[132:133], v[20:21], v[150:151] op_sel:[0,1,0] op_sel_hi:[1,1,1]
    v_pk_mul_f32 v[136:137], v[134:135], v[20:21] op_sel_hi:[1,0]
    v_pk_mul_f32 v[152:153], v[150:151], v[20:21] op_sel_hi:[1,0]
    v_pk_fma_f32 v[136:137], v[150:151], v[20:21], v[136:137] op_sel:[0,1,0] op_sel_hi:[1,1,1] neg_lo:[0,1,0] neg_hi:[0,1,0]
    v_pk_fma_f32 v[152:153], v[134:135], v[20:21], v[152:153] op_sel:[0,1,0] op_sel_hi:[1,1,1]
    v_pk_mul_f32 v[138:139], v[136:137], v[20:21] op_sel_hi:[1,0]
    v_pk_mul_f32 v[154:155], v[152:153], v[20:21] op_sel_hi:[1,0]
    v_pk_fma_f32 v[138:139], v[152:153], v[20:21], v[138:139] op_sel:[0,1,0] op_sel_hi:[1,1,1] neg_lo:[0,1,0] neg_hi:[0,1,0]
    v_pk_fma_f32 v[154:155], v[136:137], v[20:21], v[154:155] op_sel:[0,1,0] op_sel_hi:[1,1,1]
    v_pk_mul_f32 v[140:141], v[138:139], v[20:21] op_sel_hi:[1,0]
    v_pk_mul_f32 v[156:157], v[154:155], v[20:21] op_sel_hi:[1,0]
    v_pk_fma_f32 v[140:141], v[154:155], v[20:21], v[140:141] op_sel:[0,1,0] op_sel_hi:[1,1,1] neg_lo:[0,1,0] neg_hi:[0,1,0]
    v_pk_fma_f32 v[156:157], v[138:139], v[20:21], v[156:157] op_sel:[0,1,0] op_sel_hi:[1,1,1]
    v_pk_mul_f32 v[142:143], v[140:141], v[20:21] op_sel_hi:[1,0]
    v_pk_mul_f32 v[158:159], v[156:157], v[20:21] op_sel_hi:[1,0]
    v_pk_fma_f32 v[142:143], v[156:157], v[20:21], v[142:143] op_sel:[0,1,0] op_sel_hi:[1,1,1] neg_lo:[0,1,0] neg_hi:[0,1,0]
    v_pk_fma_f32 v[158:159], v[140:141], v[20:21], v[158:159] op_sel:[0,1,0] op_sel_hi:[1,1,1]
    v_cvt_pk_bf16_f32 v240, v128, v129
    v_cvt_pk_bf16_f32 v241, v144, v145
    v_cvt_pk_bf16_f32 v242, -v144, -v145
    v_accvgpr_write_b32 a24, v240
    v_accvgpr_write_b32 a32, v241
    v_accvgpr_write_b32 a40, v242
    v_cvt_pk_bf16_f32 v244, v130, v131
    v_cvt_pk_bf16_f32 v245, v146, v147
    v_cvt_pk_bf16_f32 v246, -v146, -v147
    v_accvgpr_write_b32 a25, v244
    v_accvgpr_write_b32 a33, v245
    v_accvgpr_write_b32 a41, v246
    v_cvt_pk_bf16_f32 v240, v132, v133
    v_cvt_pk_bf16_f32 v241, v148, v149
    v_cvt_pk_bf16_f32 v242, -v148, -v149
    v_accvgpr_write_b32 a26, v240
    v_accvgpr_write_b32 a34, v241
    v_accvgpr_write_b32 a42, v242
    v_cvt_pk_bf16_f32 v244, v134, v135
    v_cvt_pk_bf16_f32 v245, v150, v151
    v_cvt_pk_bf16_f32 v246, -v150, -v151
    v_accvgpr_write_b32 a27, v244
    v_accvgpr_write_b32 a35, v245
    v_accvgpr_write_b32 a43, v246
    v_cvt_pk_bf16_f32 v240, v136, v137
    v_cvt_pk_bf16_f32 v241, v152, v153
    v_cvt_pk_bf16_f32 v242, -v152, -v153
    v_accvgpr_write_b32 a28, v240
    v_accvgpr_write_b32 a36, v241
    v_accvgpr_write_b32 a44, v242
    v_cvt_pk_bf16_f32 v244, v138, v139
    v_cvt_pk_bf16_f32 v245, v154, v155
    v_cvt_pk_bf16_f32 v246, -v154, -v155
    v_accvgpr_write_b32 a29, v244
    v_accvgpr_write_b32 a37, v245
    v_accvgpr_write_b32 a45, v246
    v_cvt_pk_bf16_f32 v240, v140, v141
    v_cvt_pk_bf16_f32 v241, v156, v157
    v_cvt_pk_bf16_f32 v242, -v156, -v157
    v_accvgpr_write_b32 a30, v240
    v_accvgpr_write_b32 a38, v241
    v_accvgpr_write_b32 a46, v242
    v_cvt_pk_bf16_f32 v244, v142, v143
    v_cvt_pk_bf16_f32 v245, v158, v159
    v_cvt_pk_bf16_f32 v246, -v158, -v159
    v_accvgpr_write_b32 a31, v244
    v_accvgpr_write_b32 a39, v245
    v_accvgpr_write_b32 a47, v246
    s_waitcnt vmcnt(4)
    s_barrier
    s_cmp_lg_u32 s36, 0
    s_cbranch_scc1 L_sf_3
    v_mov_b32 v30, s95
    s_lshl_b32 s41, s2, 6
    s_add_u32 s41, s41, 1048576
    v_lshlrev_b32_e64 v31, 14, v1
    s_mov_b64 exec, 0xff
    buffer_store_dword v30, v31, s[12:15], s41 offen sc1
    s_mov_b64 exec, -1
L_sf_3:
    s_mov_b32 s41, s92
    s_mov_b32 s42, s93
    v_mov_b32 v28, v18
    v_mov_b32_e64 v29, v19
    buffer_load_dwordx4 a[224:227], v28, s[28:31], s41 offen
    buffer_load_dwordx4 a[228:231], v28, s[28:31], s42 offen
    buffer_load_dword a240, v29, s[28:31], s41 offen offset:512
    buffer_load_dwordx4 a[232:235], v28, s[32:35], s41 offen
    buffer_load_dwordx4 a[236:239], v28, s[32:35], s42 offen
    buffer_load_dword a241, v29, s[32:35], s41 offen offset:512
    v_mul_f32 v28, 0x3a000000, v25
    v_mul_f32 v27, v28, v8
    v_add_f32 v23, v27, v28
    v_cos_f32 v32, v27
    v_sin_f32 v48, v27
    v_cos_f32 v33, v23
    v_sin_f32 v49, v23
    v_add_f32 v23, v28, v28
    v_cos_f32 v20, v23
    v_sin_f32 v21, v23
    s_nop 0
    v_pk_mul_f32 v[34:35], v[32:33], v[20:21] op_sel_hi:[1,0]
    v_pk_mul_f32 v[50:51], v[48:49], v[20:21] op_sel_hi:[1,0]
    v_pk_fma_f32 v[34:35], v[48:49], v[20:21], v[34:35] op_sel:[0,1,0] op_sel_hi:[1,1,1] neg_lo:[0,1,0] neg_hi:[0,1,0]
    v_pk_fma_f32 v[50:51], v[32:33], v[20:21], v[50:51] op_sel:[0,1,0] op_sel_hi:[1,1,1]
    v_pk_mul_f32 v[36:37], v[34:35], v[20:21] op_sel_hi:[1,0]
    v_pk_mul_f32 v[52:53], v[50:51], v[20:21] op_sel_hi:[1,0]
    v_pk_fma_f32 v[36:37], v[50:51], v[20:21], v[36:37] op_sel:[0,1,0] op_sel_hi:[1,1,1] neg_lo:[0,1,0] neg_hi:[0,1,0]
    v_pk_fma_f32 v[52:53], v[34:35], v[20:21], v[52:53] op_sel:[0,1,0] op_sel_hi:[1,1,1]
    v_pk_mul_f32 v[38:39], v[36:37], v[20:21] op_sel_hi:[1,0]
    v_pk_mul_f32 v[54:55], v[52:53], v[20:21] op_sel_hi:[1,0]
    v_pk_fma_f32 v[38:39], v[52:53], v[20:21], v[38:39] op_sel:[0,1,0] op_sel_hi:[1,1,1] neg_lo:[0,1,0] neg_hi:[0,1,0]
    v_pk_fma_f32 v[54:55], v[36:37], v[20:21], v[54:55] op_sel:[0,1,0] op_sel_hi:[1,1,1]
    v_pk_mul_f32 v[40:41], v[38:39], v[20:21] op_sel_hi:[1,0]
    v_pk_mul_f32 v[56:57], v[54:55], v[20:21] op_sel_hi:[1,0]
    v_pk_fma_f32 v[40:41], v[54:55], v[20:21], v[40:41] op_sel:[0,1,0] op_sel_hi:[1,1,1] neg_lo:[0,1,0] neg_hi:[0,1,0]
    v_pk_fma_f32 v[56:57], v[38:39], v[20:21], v[56:57] op_sel:[0,1,0] op_sel_hi:[1,1,1]
    v_pk_mul_f32 v[42:43], v[40:41], v[20:21] op_sel_hi:[1,0]
    v_pk_mul_f32 v[58:59], v[56:57], v[20:21] op_sel_hi:[1,0]
    v_pk_fma_f32 v[42:43], v[56:57], v[20:21], v[42:43] op_sel:[0,1,0] op_sel_hi:[1,1,1] neg_lo:[0,1,0] neg_hi:[0,1,0]
    v_pk_fma_f32 v[58:59], v[40:41], v[20:21], v[58:59] op_sel:[0,1,0] op_sel_hi:[1,1,1]
    v_pk_mul_f32 v[44:45], v[42:43], v[20:21] op_sel_hi:[1,0]
    v_pk_mul_f32 v[60:61], v[58:59], v[20:21] op_sel_hi:[1,0]
    v_pk_fma_f32 v[44:45], v[58:59], v[20:21], v[44:45] op_sel:[0,1,0] op_sel_hi:[1,1,1] neg_lo:[0,1,0] neg_hi:[0,1,0]
    v_pk_fma_f32 v[60:61], v[42:43], v[20:21], v[60:61] op_sel:[0,1,0] op_sel_hi:[1,1,1]
    v_pk_mul_f32 v[46:47], v[44:45], v[20:21] op_sel_hi:[1,0]
    v_pk_mul_f32 v[62:63], v[60:61], v[20:21] op_sel_hi:[1,0]
    v_pk_fma_f32 v[46:47], v[60:61], v[20:21], v[46:47] op_sel:[0,1,0] op_sel_hi:[1,1,1] neg_lo:[0,1,0] neg_hi:[0,1,0]
    v_pk_fma_f32 v[62:63], v[44:45], v[20:21], v[62:63] op_sel:[0,1,0] op_sel_hi:[1,1,1]
    v_fma_f32 v25, 2.0, v8, v26
    v_mul_f32_e64 v25, v25, v4
    v_mul_f32 v28, 0x3d000000, v4
    v_mul_f32 v27, 0x3c800000, v25
    v_add_f32 v23, v27, v28
    v_cos_f32 v128, v27
    v_sin_f32 v144, v27
    v_cos_f32 v129, v23
    v_sin_f32 v145, v23
    v_add_f32 v23, v28, v28
    v_cos_f32 v20, v23
    v_sin_f32 v21, v23
    s_nop 0
    s_nop 0
    v_pk_mul_f32 v[130:131], v[128:129], v[20:21] op_sel_hi:[1,0]
    v_pk_mul_f32 v[146:147], v[144:145], v[20:21] op_sel_hi:[1,0]
    v_pk_fma_f32 v[130:131], v[144:145], v[20:21], v[130:131] op_sel:[0,1,0] op_sel_hi:[1,1,1] neg_lo:[0,1,0] neg_hi:[0,1,0]
    v_pk_fma_f32 v[146:147], v[128:129], v[20:21], v[146:147] op_sel:[0,1,0] op_sel_hi:[1,1,1]
    v_pk_mul_f32 v[132:133], v[130:131], v[20:21] op_sel_hi:[1,0]
    v_pk_mul_f32 v[148:149], v[146:147], v[20:21] op_sel_hi:[1,0]
    v_pk_fma_f32 v[132:133], v[146:147], v[20:21], v[132:133] op_sel:[0,1,0] op_sel_hi:[1,1,1] neg_lo:[0,1,0] neg_hi:[0,1,0]
    v_pk_fma_f32 v[148:149], v[130:131], v[20:21], v[148:149] op_sel:[0,1,0] op_sel_hi:[1,1,1]
    v_pk_mul_f32 v[134:135], v[132:133], v[20:21] op_sel_hi:[1,0]
    v_pk_mul_f32 v[150:151], v[148:149], v[20:21] op_sel_hi:[1,0]
    v_pk_fma_f32 v[134:135], v[148:149], v[20:21], v[134:135] op_sel:[0,1,0] op_sel_hi:[1,1,1] neg_lo:[0,1,0] neg_hi:[0,1,0]
    v_pk_fma_f32 v[150:151], v[132:133], v[20:21], v[150:151] op_sel:[0,1,0] op_sel_hi:[1,1,1]
    v_pk_mul_f32 v[136:137], v[134:135], v[20:21] op_sel_hi:[1,0]
    v_pk_mul_f32 v[152:153], v[150:151], v[20:21] op_sel_hi:[1,0]
    v_pk_fma_f32 v[136:137], v[150:151], v[20:21], v[136:137] op_sel:[0,1,0] op_sel_hi:[1,1,1] neg_lo:[0,1,0] neg_hi:[0,1,0]
    v_pk_fma_f32 v[152:153], v[134:135], v[20:21], v[152:153] op_sel:[0,1,0] op_sel_hi:[1,1,1]
    v_pk_mul_f32 v[138:139], v[136:137], v[20:21] op_sel_hi:[1,0]
    v_pk_mul_f32 v[154:155], v[152:153], v[20:21] op_sel_hi:[1,0]
    v_pk_fma_f32 v[138:139], v[152:153], v[20:21], v[138:139] op_sel:[0,1,0] op_sel_hi:[1,1,1] neg_lo:[0,1,0] neg_hi:[0,1,0]
    v_pk_fma_f32 v[154:155], v[136:137], v[20:21], v[154:155] op_sel:[0,1,0] op_sel_hi:[1,1,1]
    v_pk_mul_f32 v[140:141], v[138:139], v[20:21] op_sel_hi:[1,0]
    v_pk_mul_f32 v[156:157], v[154:155], v[20:21] op_sel_hi:[1,0]
    v_pk_fma_f32 v[140:141], v[154:155], v[20:21], v[140:141] op_sel:[0,1,0] op_sel_hi:[1,1,1] neg_lo:[0,1,0] neg_hi:[0,1,0]
    v_pk_fma_f32 v[156:157], v[138:139], v[20:21], v[156:157] op_sel:[0,1,0] op_sel_hi:[1,1,1]
    v_pk_mul_f32 v[142:143], v[140:141], v[20:21] op_sel_hi:[1,0]
    v_pk_mul_f32 v[158:159], v[156:157], v[20:21] op_sel_hi:[1,0]
    v_pk_fma_f32 v[142:143], v[156:157], v[20:21], v[142:143] op_sel:[0,1,0] op_sel_hi:[1,1,1] neg_lo:[0,1,0] neg_hi:[0,1,0]
    v_pk_fma_f32 v[158:159], v[140:141], v[20:21], v[158:159] op_sel:[0,1,0] op_sel_hi:[1,1,1]
    v_cvt_pk_bf16_f32 v240, v128, v129
    v_cvt_pk_bf16_f32 v241, v144, v145
    v_cvt_pk_bf16_f32 v242, -v144, -v145
    v_accvgpr_write_b32 a48, v240
    v_accvgpr_write_b32 a56, v241
    v_accvgpr_write_b32 a64, v242
    v_cvt_pk_bf16_f32 v244, v130, v131
    v_cvt_pk_bf16_f32 v245, v146, v147
    v_cvt_pk_bf16_f32 v246, -v146, -v147
    v_accvgpr_write_b32 a49, v244
    v_accvgpr_write_b32 a57, v245
    v_accvgpr_write_b32 a65, v246
    v_cvt_pk_bf16_f32 v240, v132, v133
    v_cvt_pk_bf16_f32 v241, v148, v149
    v_cvt_pk_bf16_f32 v242, -v148, -v149
    v_accvgpr_write_b32 a50, v240
    v_accvgpr_write_b32 a58, v241
    v_accvgpr_write_b32 a66, v242
    v_cvt_pk_bf16_f32 v244, v134, v135
    v_cvt_pk_bf16_f32 v245, v150, v151
    v_cvt_pk_bf16_f32 v246, -v150, -v151
    v_accvgpr_write_b32 a51, v244
    v_accvgpr_write_b32 a59, v245
    v_accvgpr_write_b32 a67, v246
    v_cvt_pk_bf16_f32 v240, v136, v137
    v_cvt_pk_bf16_f32 v241, v152, v153
    v_cvt_pk_bf16_f32 v242, -v152, -v153
    v_accvgpr_write_b32 a52, v240
    v_accvgpr_write_b32 a60, v241
    v_accvgpr_write_b32 a68, v242
    v_cvt_pk_bf16_f32 v244, v138, v139
    v_cvt_pk_bf16_f32 v245, v154, v155
    v_cvt_pk_bf16_f32 v246, -v154, -v155
    v_accvgpr_write_b32 a53, v244
    v_accvgpr_write_b32 a61, v245
    v_accvgpr_write_b32 a69, v246
    v_cvt_pk_bf16_f32 v240, v140, v141
    v_cvt_pk_bf16_f32 v241, v156, v157
    v_cvt_pk_bf16_f32 v242, -v156, -v157
    v_accvgpr_write_b32 a54, v240
    v_accvgpr_write_b32 a62, v241
    v_accvgpr_write_b32 a70, v242
    v_cvt_pk_bf16_f32 v244, v142, v143
    v_cvt_pk_bf16_f32 v245, v158, v159
    v_cvt_pk_bf16_f32 v246, -v158, -v159
    v_accvgpr_write_b32 a55, v244
    v_accvgpr_write_b32 a63, v245
    v_accvgpr_write_b32 a71, v246
    v_mul_f32 v28, 0x3a800000, v4
    v_mul_f32 v27, 0x3a000000, v25
    s_mov_b32 s62, 0x3a000000
    v_add_f32 v23, v27, v28
    v_cos_f32 v64, v27
    v_sin_f32 v80, v27
    v_cos_f32 v65, v23
    v_sin_f32 v81, v23
    v_add_f32 v23, v28, v28
    v_cos_f32 v20, v23
    v_sin_f32 v21, v23
    v_pk_mul_f32 v[64:65], v[64:65], s[62:63] op_sel_hi:[1,0]
    v_pk_mul_f32 v[80:81], v[80:81], s[62:63] op_sel_hi:[1,0]
    v_pk_mul_f32 v[66:67], v[64:65], v[20:21] op_sel_hi:[1,0]
    v_pk_mul_f32 v[82:83], v[80:81], v[20:21] op_sel_hi:[1,0]
    v_pk_fma_f32 v[66:67], v[80:81], v[20:21], v[66:67] op_sel:[0,1,0] op_sel_hi:[1,1,1] neg_lo:[0,1,0] neg_hi:[0,1,0]
    v_pk_fma_f32 v[82:83], v[64:65], v[20:21], v[82:83] op_sel:[0,1,0] op_sel_hi:[1,1,1]
    v_pk_mul_f32 v[68:69], v[66:67], v[20:21] op_sel_hi:[1,0]
    v_pk_mul_f32 v[84:85], v[82:83], v[20:21] op_sel_hi:[1,0]
    v_pk_fma_f32 v[68:69], v[82:83], v[20:21], v[68:69] op_sel:[0,1,0] op_sel_hi:[1,1,1] neg_lo:[0,1,0] neg_hi:[0,1,0]
    v_pk_fma_f32 v[84:85], v[66:67], v[20:21], v[84:85] op_sel:[0,1,0] op_sel_hi:[1,1,1]
    v_pk_mul_f32 v[70:71], v[68:69], v[20:21] op_sel_hi:[1,0]
    v_pk_mul_f32 v[86:87], v[84:85], v[20:21] op_sel_hi:[1,0]
    v_pk_fma_f32 v[70:71], v[84:85], v[20:21], v[70:71] op_sel:[0,1,0] op_sel_hi:[1,1,1] neg_lo:[0,1,0] neg_hi:[0,1,0]
    v_pk_fma_f32 v[86:87], v[68:69], v[20:21], v[86:87] op_sel:[0,1,0] op_sel_hi:[1,1,1]
    v_pk_mul_f32 v[72:73], v[70:71], v[20:21] op_sel_hi:[1,0]
    v_pk_mul_f32 v[88:89], v[86:87], v[20:21] op_sel_hi:[1,0]
    v_pk_fma_f32 v[72:73], v[86:87], v[20:21], v[72:73] op_sel:[0,1,0] op_sel_hi:[1,1,1] neg_lo:[0,1,0] neg_hi:[0,1,0]
    v_pk_fma_f32 v[88:89], v[70:71], v[20:21], v[88:89] op_sel:[0,1,0] op_sel_hi:[1,1,1]
    v_pk_mul_f32 v[74:75], v[72:73], v[20:21] op_sel_hi:[1,0]
    v_pk_mul_f32 v[90:91], v[88:89], v[20:21] op_sel_hi:[1,0]
    v_pk_fma_f32 v[74:75], v[88:89], v[20:21], v[74:75] op_sel:[0,1,0] op_sel_hi:[1,1,1] neg_lo:[0,1,0] neg_hi:[0,1,0]
    v_pk_fma_f32 v[90:91], v[72:73], v[20:21], v[90:91] op_sel:[0,1,0] op_sel_hi:[1,1,1]
    v_pk_mul_f32 v[76:77], v[74:75], v[20:21] op_sel_hi:[1,0]
    v_pk_mul_f32 v[92:93], v[90:91], v[20:21] op_sel_hi:[1,0]
    v_pk_fma_f32 v[76:77], v[90:91], v[20:21], v[76:77] op_sel:[0,1,0] op_sel_hi:[1,1,1] neg_lo:[0,1,0] neg_hi:[0,1,0]
    v_pk_fma_f32 v[92:93], v[74:75], v[20:21], v[92:93] op_sel:[0,1,0] op_sel_hi:[1,1,1]
    v_pk_mul_f32 v[78:79], v[76:77], v[20:21] op_sel_hi:[1,0]
    v_pk_mul_f32 v[94:95], v[92:93], v[20:21] op_sel_hi:[1,0]
    v_pk_fma_f32 v[78:79], v[92:93], v[20:21], v[78:79] op_sel:[0,1,0] op_sel_hi:[1,1,1] neg_lo:[0,1,0] neg_hi:[0,1,0]
    v_pk_fma_f32 v[94:95], v[76:77], v[20:21], v[94:95] op_sel:[0,1,0] op_sel_hi:[1,1,1]
    v_mov_b32 v21, v17
    v_bfe_u32 v28, v0, 2, 5
    v_and_b32 v27, 3, v28
    v_bfe_u32 v26, v28, 4, 1
    v_lshl_or_b32 v27, v26, 2, v27
    v_bfe_u32 v26, v28, 2, 2
    v_lshl_or_b32 v27, v26, 3, v27
    v_lshlrev_b32 v27, 4, v27
    v_lshrrev_b32 v26, 7, v0
    v_lshl_add_u32 v27, v26, 3, v27
    v_and_b32 v26, 3, v0
    v_lshl_add_u32 v18, v26, 12, v27
    v_add_u32 v18, 0, v18
    v_xor_b32_e64 v26, 1, v26
    v_lshl_add_u32 v19, v26, 12, v27
    v_add_u32 v19, 2048, v19
    s_add_u32 s42, s58, 16777216
    s_mov_b32 s90, s42
    s_add_u32 s91, s42, 4096
    s_add_u32 s92, s42, 8192
    s_add_u32 s93, s42, 12288
    s_lshl_b32 s61, s36, 10
    s_add_u32 s52, s61, 262144
    s_add_u32 s53, s52, 4096
    s_lshr_b32 s54, s59, 8
    s_add_u32 s54, s54, 278528
    v_and_b32 v20, 15, v1
    v_lshlrev_b32 v20, 2, v20
    s_lshl_b32 s42, s36, 12
    s_add_u32 s63, s58, s42
    s_add_u32 s94, s63, 25165824
    s_waitcnt vmcnt(6)
    s_barrier
    s_cmp_lg_u32 s36, 0
    s_cbranch_scc1 L_sf_4
    v_mov_b32 v30, s95
    s_lshl_b32 s41, s2, 6
    s_add_u32 s41, s41, 1179648
    v_lshlrev_b32 v31, 14, v1
    s_mov_b64 exec, 0xff
    buffer_store_dword v30, v31, s[12:15], s41 offen sc1
    s_mov_b64 exec, -1
L_sf_4:
    s_waitcnt vmcnt(1)
    s_cmp_eq_u32 s36, 0
    s_cbranch_scc1 L_wbl
    s_waitcnt vmcnt(0)
L_wbl:
    s_mul_i32 s41, s36, 2112
    s_add_u32 s41, s41, 106240
    v_and_b32 v30, 31, v1
    v_lshlrev_b32_e64 v30, 4, v30
    v_mul_u32_u24 v31, 528, v3
    v_add3_u32 v30, v30, v31, s41
    v_and_b32 v31, 3, v1
    v_mul_u32_u24 v31, 528, v31
    v_add_u32 v31, s41, v31
    ds_write_b128 v30, a[224:227] offset:0
    ds_write_b128 v30, a[228:231] offset:1056
    ds_write_b32 v31, a240 offset:512
    ds_write_b128 v30, a[232:235] offset:8448
    ds_write_b128 v30, a[236:239] offset:9504
    ds_write_b32 v31, a241 offset:8960
    s_and_b32 s87, s2, 7
    s_lshl_b32 s87, s87, 14
    s_add_u32 s87, s87, 1048576
    s_add_u32 s55, s87, 131072
    v_lshlrev_b32 v25, 6, v0
    s_mov_b32 s46, 0
L_pf_5:
    buffer_load_dword v24, v25, s[12:15], s87 offen sc1
    s_waitcnt vmcnt(0)
L_pf_5_c:
    v_cmp_ne_u32 vcc, s95, v24
    s_add_u32 s46, s46, 1
    s_cmp_ge_u32 s46, 262144
    s_cbranch_scc1 L_fail
    s_mov_b64 exec, vcc
    s_cbranch_execnz L_pf_5
    s_mov_b64 exec, -1
    s_waitcnt lgkmcnt(0)
    s_barrier
    s_nop 0
    buffer_load_dwordx4 v[128:131], v6, s[12:15], s90 offen offset:0 sc1
    buffer_load_dwordx4 v[132:135], v6, s[12:15], s91 offen offset:0 sc1
    buffer_load_dwordx4 v[136:139], v6, s[12:15], s92 offen offset:0 sc1
    buffer_load_dwordx4 v[140:143], v6, s[12:15], s93 offen offset:0 sc1
    buffer_load_dwordx4 v[248:251], v5, s[12:15], s52 offen offset:0 sc1
    buffer_load_dwordx4 v[252:255], v5, s[12:15], s53 offen offset:0 sc1
    buffer_load_dword v23, v20, s[12:15], s54 offen sc1
    v_lshrrev_b32 v28, 2, v0
    v_and_b32 v29, 3, v0
    v_mul_u32_u24 v29, 528, v29
    s_and_b32 s48, s2, 2
    s_add_u32 s48, s48, 106240
    v_add_u32 v29, s48, v29
    s_and_b32 s49, s2, 1
    s_sub_u32 s49, 0, s49
    v_add_u32 v30, 0, v28
    v_xor_b32 v30, s49, v30
    v_subrev_u32_e64 v30, s49, v30
    v_and_b32 v30, 0xff, v30
    v_lshl_add_u32 v30, v30, 1, v29
    ds_read_u16 v176, v30 offset:0
    ds_read_u16 v160, v30 offset:8448
    ds_read_u16 v177, v30 offset:2112
    ds_read_u16 v161, v30 offset:10560
    ds_read_u16 v178, v30 offset:4224
    ds_read_u16 v162, v30 offset:12672
    ds_read_u16 v179, v30 offset:6336
    ds_read_u16 v163, v30 offset:14784
    v_add_u32 v30, 64, v28
    v_xor_b32 v30, s49, v30
    v_subrev_u32_e64 v30, s49, v30
    v_and_b32 v30, 0xff, v30
    v_lshl_add_u32 v30, v30, 1, v29
    ds_read_u16 v180, v30 offset:0
    ds_read_u16 v164, v30 offset:8448
    ds_read_u16 v181, v30 offset:2112
    ds_read_u16 v165, v30 offset:10560
    ds_read_u16 v182, v30 offset:4224
    ds_read_u16 v166, v30 offset:12672
    ds_read_u16 v183, v30 offset:6336
    ds_read_u16 v167, v30 offset:14784
    v_add_u32 v30, 128, v28
    v_xor_b32 v30, s49, v30
    v_subrev_u32 v30, s49, v30
    v_and_b32 v30, 0xff, v30
    v_lshl_add_u32 v30, v30, 1, v29
    ds_read_u16 v184, v30 offset:0
    ds_read_u16 v168, v30 offset:8448
    ds_read_u16 v185, v30 offset:2112
    ds_read_u16 v169, v30 offset:10560
    ds_read_u16 v186, v30 offset:4224
    ds_read_u16 v170, v30 offset:12672
    ds_read_u16 v187, v30 offset:6336
    ds_read_u16 v171, v30 offset:14784
    v_add_u32 v30, 192, v28
    v_xor_b32 v30, s49, v30
    v_subrev_u32 v30, s49, v30
    v_and_b32 v30, 0xff, v30
    v_lshl_add_u32 v30, v30, 1, v29
    ds_read_u16 v188, v30 offset:0
    ds_read_u16 v172, v30 offset:8448
    ds_read_u16 v189, v30 offset:2112
    ds_read_u16 v173, v30 offset:10560
    ds_read_u16 v190, v30 offset:4224
    ds_read_u16 v174, v30 offset:12672
    ds_read_u16 v191, v30 offset:6336
    ds_read_u16 v175, v30 offset:14784
    s_add_u32 s48, s57, 33554432
    s_waitcnt lgkmcnt(15)
    s_nop 0
    v_lshl_or_b32 v176, v160, 16, v176
    v_lshl_or_b32 v177, v161, 16, v177
    v_lshl_or_b32 v178, v162, 16, v178
    v_lshl_or_b32 v179, v163, 16, v179
    s_waitcnt lgkmcnt(15)
    s_nop 0
    v_lshl_or_b32 v180, v164, 16, v180
    v_lshl_or_b32 v181, v165, 16, v181
    v_lshl_or_b32 v182, v166, 16, v182
    v_lshl_or_b32 v183, v167, 16, v183
    s_waitcnt lgkmcnt(8)
    s_nop 0
    v_lshl_or_b32 v184, v168, 16, v184
    v_lshl_or_b32 v185, v169, 16, v185
    v_lshl_or_b32 v186, v170, 16, v186
    v_lshl_or_b32 v187, v171, 16, v187
    s_waitcnt lgkmcnt(0)
    s_nop 0
    v_lshl_or_b32 v188, v172, 16, v188
    v_lshl_or_b32 v189, v173, 16, v189
    v_lshl_or_b32 v190, v174, 16, v190
    v_lshl_or_b32 v191, v175, 16, v191
    buffer_load_dword v24, v25, s[12:15], s55 offen sc1
    s_waitcnt vmcnt(4)
    s_nop 0
    ds_write_b64 v18, v[128:129] offset:0
    ds_write_b64 v19, v[130:131] offset:0
    ds_write_b64 v18, v[132:133] offset:1024
    ds_write_b64 v19, v[134:135] offset:1024
    ds_write_b64 v18, v[136:137] offset:512
    ds_write_b64 v19, v[138:139] offset:512
    ds_write_b64 v18, v[140:141] offset:1536
    ds_write_b64 v19, v[142:143] offset:1536
    s_waitcnt vmcnt(0)
    s_mov_b32 s46, 0
    s_branch L_pf_6_c
L_pf_6:
    buffer_load_dword v24, v25, s[12:15], s55 offen sc1
    s_waitcnt vmcnt(0)
L_pf_6_c:
    v_cmp_ne_u32 vcc, s95, v24
    s_add_u32 s46, s46, 1
    s_cmp_ge_u32 s46, 262144
    s_cbranch_scc1 L_fail
    s_mov_b64 exec, vcc
    s_cbranch_execnz L_pf_6
    s_mov_b64 exec, -1
    s_waitcnt lgkmcnt(0)
    s_barrier
    buffer_load_dwordx4 v[112:115], v5, s[12:15], s94 offen offset:0 sc1
    buffer_load_dwordx4 v[116:119], v5, s[12:15], s94 offen offset:1024 sc1
    buffer_load_dwordx4 v[120:123], v5, s[12:15], s94 offen offset:2048 sc1
    buffer_load_dwordx4 v[124:127], v5, s[12:15], s94 offen offset:3072 sc1
    s_cmp_lg_u32 s2, 0
    s_cbranch_scc1 L_x0_7
    s_add_u32 s44, s61, 270336
    s_add_u32 s45, s44, 4096
    buffer_load_dwordx4 a[192:195], v5, s[12:15], s44 offen offset:0 sc1
    buffer_load_dwordx4 a[196:199], v5, s[12:15], s45 offen offset:0 sc1
    s_cmp_eq_u32 s39, 0
    s_cbranch_scc1 L_x0_7
    s_add_u32 s42, s94, 4194304
    buffer_load_dwordx4 a[160:163], v5, s[12:15], s42 offen offset:0 sc1
    buffer_load_dwordx4 a[164:167], v5, s[12:15], s42 offen offset:1024 sc1
    buffer_load_dwordx4 a[168:171], v5, s[12:15], s42 offen offset:2048 sc1
    buffer_load_dwordx4 a[172:175], v5, s[12:15], s42 offen offset:3072 sc1
L_x0_7:
    s_mov_b32 s40, 0
    s_lshl_b32 s64, s2, 6
    s_add_u32 s64, s64, 2097152
    s_add_u32 s65, s59, 2097152
    s_lshr_b32 s42, s2, 7
    s_lshl_b32 s42, s42, 15
    s_lshr_b32 s66, s59, 8
    s_add_u32 s66, s66, s42
    s_add_u32 s66, s66, 286720
    s_and_b32 s43, s2, 7
    s_lshl_b32 s43, s43, 13
    s_add_u32 s67, s43, s61
    s_nop 0
    s_add_u32 s67, s67, 286720
    ds_read_b128 v[224:227], v10 offset:0
    ds_read_b128 v[232:235], v10 offset:2048
    ds_read_b128 v[228:231], v10 offset:1024
    ds_read_b128 v[236:239], v10 offset:3072
    ds_read_b64 v[192:193], v11 offset:0
    ds_read_b64 v[194:195], v11 offset:2048
    ds_read_b64 v[196:197], v11 offset:4096
    ds_read_b64 v[198:199], v11 offset:6144
    ds_read_b64 v[200:201], v11 offset:8192
    ds_read_b64 v[202:203], v11 offset:10240
    ds_read_b64 v[204:205], v11 offset:12288
    ds_read_b64 v[206:207], v11 offset:14336
    s_waitcnt lgkmcnt(10)
    v_mfma_f32_32x32x16_bf16 v[128:143], v[224:227], a[24:27], 0
    s_waitcnt lgkmcnt(0)
    v_lshlrev_b32 v24, 16, v192
    v_and_b32 v25, 0xffff0000, v192
    v_lshlrev_b32 v26, 16, v196
    v_and_b32 v27, 0xffff0000, v196
    v_add_f32 v160, v24, v26
    v_mfma_f32_32x32x16_bf16 v[144:159], v[232:235], a[24:27], 0
    v_add_f32 v161, v25, v27
    v_sub_f32 v168, v24, v26
    v_sub_f32 v169, v25, v27
    v_mul_f32 v160, v160, v248
    v_mul_f32 v161, v161, v249
    v_mul_f32 v168, v168, v252
    v_mfma_f32_32x32x16_bf16 v[128:143], v[232:235], a[32:35], v[128:143]
    v_mul_f32 v169, v169, v253
    v_lshlrev_b32 v24, 16, v193
    v_and_b32 v25, 0xffff0000, v193
    v_lshlrev_b32 v26, 16, v197
    v_and_b32 v27, 0xffff0000, v197
    v_add_f32 v162, v24, v26
    v_mfma_f32_32x32x16_bf16 v[144:159], v[224:227], a[40:43], v[144:159]
    v_add_f32 v163, v25, v27
    v_sub_f32 v170, v24, v26
    v_sub_f32 v171, v25, v27
    v_mul_f32 v162, v162, v250
    v_mul_f32 v163, v163, v251
    v_mul_f32 v170, v170, v254
    v_mfma_f32_32x32x16_bf16 v[128:143], v[228:231], a[28:31], v[128:143]
    v_mul_f32 v171, v171, v255
    v_lshlrev_b32 v24, 16, v194
    v_and_b32 v25, 0xffff0000, v194
    v_lshlrev_b32 v26, 16, v198
    v_and_b32 v27, 0xffff0000, v198
    v_add_f32 v164, v24, v26
    v_mfma_f32_32x32x16_bf16 v[144:159], v[236:239], a[28:31], v[144:159]
    v_add_f32 v165, v25, v27
    v_sub_f32 v172, v24, v26
    v_sub_f32 v173, v25, v27
    v_mul_f32 v164, v164, v248
    v_mul_f32 v165, v165, v249
    v_mul_f32 v172, v172, v252
    v_mfma_f32_32x32x16_bf16 v[128:143], v[236:239], a[36:39], v[128:143]
    v_mul_f32 v173, v173, v253
    v_lshlrev_b32 v24, 16, v195
    v_and_b32 v25, 0xffff0000, v195
    v_lshlrev_b32 v26, 16, v199
    v_and_b32 v27, 0xffff0000, v199
    v_add_f32 v166, v24, v26
    v_mfma_f32_32x32x16_bf16 v[144:159], v[228:231], a[44:47], v[144:159]
    v_add_f32 v167, v25, v27
    v_sub_f32 v174, v24, v26
    v_sub_f32 v175, v25, v27
    v_mul_f32 v166, v166, v250
    v_mul_f32 v167, v167, v251
    v_mul_f32 v174, v174, v254
    v_mul_f32 v175, v175, v255
    v_pk_mul_f32 v[240:241], v[128:129], v[32:33]
    s_nop 3
    s_nop 0
    v_pk_mul_f32 v[242:243], v[144:145], v[32:33]
    v_pk_fma_f32 v[240:241], v[144:145], v[48:49], v[240:241]
    v_pk_fma_f32 v[242:243], v[128:129], v[48:49], v[242:243] neg_lo:[0,1,0] neg_hi:[0,1,0]
    v_cvt_pk_bf16_f32 v224, v240, v241
    v_cvt_pk_bf16_f32 v232, v242, v243
    v_pk_mul_f32 v[244:245], v[130:131], v[34:35]
    v_pk_mul_f32 v[246:247], v[146:147], v[34:35]
    v_pk_fma_f32 v[244:245], v[146:147], v[50:51], v[244:245]
    v_pk_fma_f32 v[246:247], v[130:131], v[50:51], v[246:247] neg_lo:[0,1,0] neg_hi:[0,1,0]
    v_cvt_pk_bf16_f32 v225, v244, v245
    v_cvt_pk_bf16_f32 v233, v246, v247
    v_pk_mul_f32 v[240:241], v[132:133], v[36:37]
    v_pk_mul_f32 v[242:243], v[148:149], v[36:37]
    v_pk_fma_f32 v[240:241], v[148:149], v[52:53], v[240:241]
    v_pk_fma_f32 v[242:243], v[132:133], v[52:53], v[242:243] neg_lo:[0,1,0] neg_hi:[0,1,0]
    v_cvt_pk_bf16_f32 v226, v240, v241
    v_cvt_pk_bf16_f32 v234, v242, v243
    v_pk_mul_f32 v[244:245], v[134:135], v[38:39]
    v_pk_mul_f32 v[246:247], v[150:151], v[38:39]
    v_pk_fma_f32 v[244:245], v[150:151], v[54:55], v[244:245]
    v_pk_fma_f32 v[246:247], v[134:135], v[54:55], v[246:247] neg_lo:[0,1,0] neg_hi:[0,1,0]
    v_cvt_pk_bf16_f32 v227, v244, v245
    v_cvt_pk_bf16_f32 v235, v246, v247
    v_pk_mul_f32 v[240:241], v[136:137], v[40:41]
    v_pk_mul_f32 v[242:243], v[152:153], v[40:41]
    v_pk_fma_f32 v[240:241], v[152:153], v[56:57], v[240:241]
    v_pk_fma_f32 v[242:243], v[136:137], v[56:57], v[242:243] neg_lo:[0,1,0] neg_hi:[0,1,0]
    v_cvt_pk_bf16_f32 v228, v240, v241
    v_cvt_pk_bf16_f32 v236, v242, v243
    v_pk_mul_f32 v[244:245], v[138:139], v[42:43]
    v_pk_mul_f32 v[246:247], v[154:155], v[42:43]
    v_pk_fma_f32 v[244:245], v[154:155], v[58:59], v[244:245]
    v_pk_fma_f32 v[246:247], v[138:139], v[58:59], v[246:247] neg_lo:[0,1,0] neg_hi:[0,1,0]
    v_cvt_pk_bf16_f32 v229, v244, v245
    v_cvt_pk_bf16_f32 v237, v246, v247
    v_pk_mul_f32 v[240:241], v[140:141], v[44:45]
    v_pk_mul_f32 v[242:243], v[156:157], v[44:45]
    v_pk_fma_f32 v[240:241], v[156:157], v[60:61], v[240:241]
    v_pk_fma_f32 v[242:243], v[140:141], v[60:61], v[242:243] neg_lo:[0,1,0] neg_hi:[0,1,0]
    v_cvt_pk_bf16_f32 v230, v240, v241
    v_cvt_pk_bf16_f32 v238, v242, v243
    v_pk_mul_f32 v[244:245], v[142:143], v[46:47]
    v_pk_mul_f32 v[246:247], v[158:159], v[46:47]
    v_pk_fma_f32 v[244:245], v[158:159], v[62:63], v[244:245]
    v_pk_fma_f32 v[246:247], v[142:143], v[62:63], v[246:247] neg_lo:[0,1,0] neg_hi:[0,1,0]
    v_cvt_pk_bf16_f32 v231, v244, v245
    v_cvt_pk_bf16_f32 v239, v246, v247
    v_mfma_f32_32x32x16_bf16 v[128:143], a[0:3], v[224:227], 0
    s_waitcnt vmcnt(0)
    s_add_u32 s49, s48, 0
    buffer_store_dwordx4 v[176:179], v21, s[12:15], s49 offen sc1
    s_add_u32 s49, s48, 1048576
    buffer_store_dwordx4 v[180:183], v9, s[12:15], s49 offen sc1
    s_add_u32 s49, s48, 2097152
    v_mfma_f32_32x32x16_bf16 v[144:159], a[0:3], v[232:235], 0
    buffer_store_dwordx4 v[184:187], v9, s[12:15], s49 offen sc1
    s_add_u32 s49, s48, 3145728
    buffer_store_dwordx4 v[188:191], v9, s[12:15], s49 offen sc1
    v_accvgpr_write_b32 a128, v112
    v_lshlrev_b32_e64 v96, 16, v112
    v_and_b32 v112, 0xffff0000, v112
    v_mfma_f32_32x32x16_bf16 v[128:143], a[8:11], v[232:235], v[128:143]
    v_accvgpr_write_b32 a129, v113
    v_lshlrev_b32_e64 v97, 16, v113
    v_and_b32 v113, 0xffff0000, v113
    v_accvgpr_write_b32 a130, v114
    v_lshlrev_b32_e64 v98, 16, v114
    v_and_b32 v114, 0xffff0000, v114
    v_mfma_f32_32x32x16_bf16 v[144:159], a[16:19], v[224:227], v[144:159]
    v_accvgpr_write_b32 a131, v115
    v_lshlrev_b32_e64 v99, 16, v115
    v_and_b32 v115, 0xffff0000, v115
    v_accvgpr_write_b32 a132, v116
    v_lshlrev_b32_e64 v100, 16, v116
    v_and_b32 v116, 0xffff0000, v116
    v_mfma_f32_32x32x16_bf16 v[128:143], a[4:7], v[228:231], v[128:143]
    v_accvgpr_write_b32 a133, v117
    v_lshlrev_b32_e64 v101, 16, v117
    v_and_b32 v117, 0xffff0000, v117
    v_accvgpr_write_b32 a134, v118
    v_lshlrev_b32_e64 v102, 16, v118
    v_and_b32 v118, 0xffff0000, v118
    v_mfma_f32_32x32x16_bf16 v[144:159], a[4:7], v[236:239], v[144:159]
    v_accvgpr_write_b32 a135, v119
    v_lshlrev_b32_e64 v103, 16, v119
    v_and_b32 v119, 0xffff0000, v119
    v_accvgpr_write_b32 a136, v120
    v_lshlrev_b32_e64 v104, 16, v120
    v_and_b32 v120, 0xffff0000, v120
    v_mfma_f32_32x32x16_bf16 v[128:143], a[12:15], v[236:239], v[128:143]
    v_accvgpr_write_b32 a137, v121
    v_lshlrev_b32_e64 v105, 16, v121
    v_and_b32 v121, 0xffff0000, v121
    v_accvgpr_write_b32 a138, v122
    v_lshlrev_b32_e64 v106, 16, v122
    v_and_b32 v122, 0xffff0000, v122
    v_mfma_f32_32x32x16_bf16 v[144:159], a[20:23], v[228:231], v[144:159]
    v_accvgpr_write_b32 a139, v123
    v_lshlrev_b32_e64 v107, 16, v123
    v_and_b32 v123, 0xffff0000, v123
    v_accvgpr_write_b32 a140, v124
    v_lshlrev_b32_e64 v108, 16, v124
    v_and_b32 v124, 0xffff0000, v124
    v_accvgpr_write_b32 a141, v125
    v_lshlrev_b32_e64 v109, 16, v125
    v_and_b32 v125, 0xffff0000, v125
    v_accvgpr_write_b32 a142, v126
    v_lshlrev_b32_e64 v110, 16, v126
    v_and_b32 v126, 0xffff0000, v126
    v_accvgpr_write_b32 a143, v127
    v_lshlrev_b32 v111, 16, v127
    v_and_b32 v127, 0xffff0000, v127
    s_cmp_lg_u32 s36, 1
    s_cbranch_scc1 L_wsp_8
    s_and_b32 s41, s2, 1
    s_lshl_b32 s42, s41, 9
    s_and_b32 s43, s2, 2
    s_add_u32 s42, s42, s43
    s_add_u32 s42, s42, 106240
    v_and_b32 v30, 3, v1
    v_lshlrev_b32 v30, 2, v30
    v_bfe_u32 v31, v1, 2, 2
    v_add_u32 v30, v30, v31
    v_mul_u32_u24 v30, 528, v30
    v_add_u32_e64 v30, s42, v30
    ds_read_u16 v24, v30
    ds_read_u16 v25, v30 offset:8448
    v_accvgpr_read_b32 v26, a246
    v_accvgpr_read_b32 v27, a247
    s_mul_i32 s41, s41, 4186112
    s_add_u32 s41, s41, s57
    s_add_u32 s41, s41, 33554432
    v_lshlrev_b32 v26, 16, v26
    v_lshlrev_b32 v27, 16, v27
    v_lshlrev_b32 v30, 2, v1
    s_waitcnt lgkmcnt(0)
    v_lshlrev_b32 v24, 16, v24
    v_lshlrev_b32 v25, 16, v25
    v_add_f32 v24, v24, v26
    v_sub_f32_e64 v25, v25, v27
    v_mul_f32 v24, 0x3e800000, v24
    v_mul_f32 v25, 0x3e800000, v25
    v_cvt_pk_bf16_f32 v24, v24, v25
    s_mov_b64 exec, 0xffff
    buffer_store_dword v24, v30, s[12:15], s41 offen sc1
    s_mov_b64 exec, -1
L_wsp_8:
    s_cmp_eq_u32 s39, 0
    s_cbranch_scc1 L_wma_9
    v_lshlrev_b32 v24, 16, v200
    v_and_b32 v25, 0xffff0000, v200
    v_lshlrev_b32 v26, 16, v204
    v_and_b32 v27, 0xffff0000, v204
    v_add_f32 v176, v24, v26
    v_add_f32 v177, v25, v27
    v_sub_f32 v184, v24, v26
    v_sub_f32 v185, v25, v27
    v_mul_f32 v176, v176, v248
    v_mul_f32 v177, v177, v249
    v_mul_f32 v184, v184, v252
    v_mul_f32 v185, v185, v253
    v_lshlrev_b32 v24, 16, v201
    v_and_b32 v25, 0xffff0000, v201
    v_lshlrev_b32 v26, 16, v205
    v_and_b32 v27, 0xffff0000, v205
    v_add_f32 v178, v24, v26
    v_add_f32 v179, v25, v27
    v_sub_f32 v186, v24, v26
    v_sub_f32 v187, v25, v27
    v_mul_f32 v178, v178, v250
    v_mul_f32 v179, v179, v251
    v_mul_f32 v186, v186, v254
    v_mul_f32 v187, v187, v255
    v_lshlrev_b32 v24, 16, v202
    v_and_b32 v25, 0xffff0000, v202
    v_lshlrev_b32 v26, 16, v206
    v_and_b32 v27, 0xffff0000, v206
    v_add_f32 v180, v24, v26
    v_add_f32 v181, v25, v27
    v_sub_f32 v188, v24, v26
    v_sub_f32 v189, v25, v27
    v_mul_f32 v180, v180, v248
    v_mul_f32 v181, v181, v249
    v_mul_f32 v188, v188, v252
    v_mul_f32 v189, v189, v253
    v_lshlrev_b32 v24, 16, v203
    v_and_b32 v25, 0xffff0000, v203
    v_lshlrev_b32 v26, 16, v207
    v_and_b32 v27, 0xffff0000, v207
    v_add_f32 v182, v24, v26
    v_add_f32 v183, v25, v27
    v_sub_f32 v190, v24, v26
    v_sub_f32 v191, v25, v27
    v_mul_f32 v182, v182, v250
    v_mul_f32 v183, v183, v251
    v_mul_f32 v190, v190, v254
    v_mul_f32_e64 v191, v191, v255
    v_accvgpr_read_b32 v208, a160
    v_accvgpr_read_b32 v209, a161
    v_accvgpr_read_b32 v210, a162
    v_accvgpr_read_b32 v211, a163
    v_accvgpr_read_b32 v212, a164
    v_accvgpr_read_b32 v213, a165
    v_accvgpr_read_b32 v214, a166
    v_accvgpr_read_b32 v215, a167
    v_accvgpr_read_b32 v216, a168
    v_accvgpr_read_b32 v217, a169
    v_accvgpr_read_b32 v218, a170
    v_accvgpr_read_b32 v219, a171
    v_accvgpr_read_b32 v220, a172
    v_accvgpr_read_b32 v221, a173
    v_accvgpr_read_b32 v222, a174
    v_accvgpr_read_b32 v223, a175
    v_lshlrev_b32 v192, 16, v208
    v_and_b32 v208, 0xffff0000, v208
    v_lshlrev_b32 v193, 16, v209
    v_and_b32 v209, 0xffff0000, v209
    v_lshlrev_b32 v194, 16, v210
    v_and_b32 v210, 0xffff0000, v210
    v_lshlrev_b32 v195, 16, v211
    v_and_b32 v211, 0xffff0000, v211
    v_lshlrev_b32 v196, 16, v212
    v_and_b32 v212, 0xffff0000, v212
    v_lshlrev_b32 v197, 16, v213
    v_and_b32 v213, 0xffff0000, v213
    v_lshlrev_b32 v198, 16, v214
    v_and_b32 v214, 0xffff0000, v214
    v_lshlrev_b32 v199, 16, v215
    v_and_b32 v215, 0xffff0000, v215
    v_lshlrev_b32 v200, 16, v216
    v_and_b32 v216, 0xffff0000, v216
    v_lshlrev_b32 v201, 16, v217
    v_and_b32 v217, 0xffff0000, v217
    v_lshlrev_b32 v202, 16, v218
    v_and_b32 v218, 0xffff0000, v218
    v_lshlrev_b32 v203, 16, v219
    v_and_b32 v219, 0xffff0000, v219
    v_lshlrev_b32 v204, 16, v220
    v_and_b32 v220, 0xffff0000, v220
    v_lshlrev_b32 v205, 16, v221
    v_and_b32 v221, 0xffff0000, v221
    v_lshlrev_b32 v206, 16, v222
    v_and_b32 v222, 0xffff0000, v222
    v_lshlrev_b32 v207, 16, v223
    v_and_b32 v223, 0xffff0000, v223
    v_pk_add_f32 v[192:193], v[96:97], v[192:193] neg_lo:[0,1] neg_hi:[0,1]
    v_pk_fma_f32 v[96:97], v[96:97], 2.0, v[192:193] op_sel_hi:[1,0,1] neg_lo:[0,0,1] neg_hi:[0,0,1]
    v_pk_add_f32 v[194:195], v[98:99], v[194:195] neg_lo:[0,1] neg_hi:[0,1]
    v_pk_fma_f32 v[98:99], v[98:99], 2.0, v[194:195] op_sel_hi:[1,0,1] neg_lo:[0,0,1] neg_hi:[0,0,1]
    v_pk_add_f32 v[196:197], v[100:101], v[196:197] neg_lo:[0,1] neg_hi:[0,1]
    v_pk_fma_f32 v[100:101], v[100:101], 2.0, v[196:197] op_sel_hi:[1,0,1] neg_lo:[0,0,1] neg_hi:[0,0,1]
    v_pk_add_f32 v[198:199], v[102:103], v[198:199] neg_lo:[0,1] neg_hi:[0,1]
    v_pk_fma_f32 v[102:103], v[102:103], 2.0, v[198:199] op_sel_hi:[1,0,1] neg_lo:[0,0,1] neg_hi:[0,0,1]
    v_pk_add_f32 v[200:201], v[104:105], v[200:201] neg_lo:[0,1] neg_hi:[0,1]
    v_pk_fma_f32 v[104:105], v[104:105], 2.0, v[200:201] op_sel_hi:[1,0,1] neg_lo:[0,0,1] neg_hi:[0,0,1]
    v_pk_add_f32 v[202:203], v[106:107], v[202:203] neg_lo:[0,1] neg_hi:[0,1]
    v_pk_fma_f32 v[106:107], v[106:107], 2.0, v[202:203] op_sel_hi:[1,0,1] neg_lo:[0,0,1] neg_hi:[0,0,1]
    v_pk_add_f32 v[204:205], v[108:109], v[204:205] neg_lo:[0,1] neg_hi:[0,1]
    v_pk_fma_f32 v[108:109], v[108:109], 2.0, v[204:205] op_sel_hi:[1,0,1] neg_lo:[0,0,1] neg_hi:[0,0,1]
    v_pk_add_f32 v[206:207], v[110:111], v[206:207] neg_lo:[0,1] neg_hi:[0,1]
    v_pk_fma_f32 v[110:111], v[110:111], 2.0, v[206:207] op_sel_hi:[1,0,1] neg_lo:[0,0,1] neg_hi:[0,0,1]
    v_pk_add_f32 v[208:209], v[112:113], v[208:209] neg_lo:[0,1] neg_hi:[0,1]
    v_pk_fma_f32 v[112:113], v[112:113], 2.0, v[208:209] op_sel_hi:[1,0,1] neg_lo:[0,0,1] neg_hi:[0,0,1]
    v_pk_add_f32 v[210:211], v[114:115], v[210:211] neg_lo:[0,1] neg_hi:[0,1]
    v_pk_fma_f32 v[114:115], v[114:115], 2.0, v[210:211] op_sel_hi:[1,0,1] neg_lo:[0,0,1] neg_hi:[0,0,1]
    v_pk_add_f32 v[212:213], v[116:117], v[212:213] neg_lo:[0,1] neg_hi:[0,1]
    v_pk_fma_f32 v[116:117], v[116:117], 2.0, v[212:213] op_sel_hi:[1,0,1] neg_lo:[0,0,1] neg_hi:[0,0,1]
    v_pk_add_f32 v[214:215], v[118:119], v[214:215] neg_lo:[0,1] neg_hi:[0,1]
    v_pk_fma_f32 v[118:119], v[118:119], 2.0, v[214:215] op_sel_hi:[1,0,1] neg_lo:[0,0,1] neg_hi:[0,0,1]
    v_pk_add_f32 v[216:217], v[120:121], v[216:217] neg_lo:[0,1] neg_hi:[0,1]
    v_pk_fma_f32 v[120:121], v[120:121], 2.0, v[216:217] op_sel_hi:[1,0,1] neg_lo:[0,0,1] neg_hi:[0,0,1]
    v_pk_add_f32 v[218:219], v[122:123], v[218:219] neg_lo:[0,1] neg_hi:[0,1]
    v_pk_fma_f32 v[122:123], v[122:123], 2.0, v[218:219] op_sel_hi:[1,0,1] neg_lo:[0,0,1] neg_hi:[0,0,1]
    v_pk_add_f32 v[220:221], v[124:125], v[220:221] neg_lo:[0,1] neg_hi:[0,1]
    v_pk_fma_f32 v[124:125], v[124:125], 2.0, v[220:221] op_sel_hi:[1,0,1] neg_lo:[0,0,1] neg_hi:[0,0,1]
    v_pk_add_f32 v[222:223], v[126:127], v[222:223] neg_lo:[0,1] neg_hi:[0,1]
    v_pk_fma_f32 v[126:127], v[126:127], 2.0, v[222:223] op_sel_hi:[1,0,1] neg_lo:[0,0,1] neg_hi:[0,0,1]
    s_mul_i32 s41, s37, 9728
    s_add_u32 s41, s41, 123136
    v_mul_u32_u24 v30, 144, v2
    v_lshrrev_b32 v28, 4, v2
    v_add_u32 v28, v28, v3
    v_lshl_add_u32 v30, v28, 6, v30
    v_add_u32 v30, s41, v30
    v_add_u32 v29, s37, v2
    v_cmp_eq_u32 vcc, 0, v29
    v_sub_u32 v29, 32, v29
    v_and_b32 v29, 31, v29
    v_lshrrev_b32 v31, 4, v29
    v_mul_u32_u24 v29, 144, v29
    v_xor_b32 v28, 1, v3
    v_add_u32 v28, v28, v31
    v_lshl_add_u32 v29, v28, 6, v29
    v_cndmask_b32 v28, 0, 4, vcc
    v_add3_u32 v29, v29, v28, s41
    v_accvgpr_write_b32 a248, v29
    v_accvgpr_write_b32 a249, v30
L_wma_9:
    s_cmp_lg_u32 s39, 0
    s_cbranch_scc1 L_psp_10
    v_pk_mul_f32 v[240:241], v[128:129], v[96:97]
    v_pk_mul_f32 v[242:243], v[144:145], v[96:97]
    v_pk_fma_f32 v[240:241], v[144:145], v[112:113], v[240:241] neg_lo:[0,1,0] neg_hi:[0,1,0]
    v_pk_fma_f32 v[242:243], v[128:129], v[112:113], v[242:243]
    v_cvt_pk_bf16_f32 v224, v240, v241
    v_cvt_pk_bf16_f32 v232, v242, v243
    v_pk_mul_f32 v[244:245], v[130:131], v[98:99]
    v_pk_mul_f32 v[246:247], v[146:147], v[98:99]
    v_pk_fma_f32 v[244:245], v[146:147], v[114:115], v[244:245] neg_lo:[0,1,0] neg_hi:[0,1,0]
    v_pk_fma_f32 v[246:247], v[130:131], v[114:115], v[246:247]
    v_cvt_pk_bf16_f32 v225, v244, v245
    v_cvt_pk_bf16_f32 v233, v246, v247
    v_pk_mul_f32 v[240:241], v[132:133], v[100:101]
    v_pk_mul_f32 v[242:243], v[148:149], v[100:101]
    v_pk_fma_f32 v[240:241], v[148:149], v[116:117], v[240:241] neg_lo:[0,1,0] neg_hi:[0,1,0]
    v_pk_fma_f32 v[242:243], v[132:133], v[116:117], v[242:243]
    v_cvt_pk_bf16_f32 v226, v240, v241
    v_cvt_pk_bf16_f32 v234, v242, v243
    v_pk_mul_f32 v[244:245], v[134:135], v[102:103]
    v_pk_mul_f32 v[246:247], v[150:151], v[102:103]
    v_pk_fma_f32 v[244:245], v[150:151], v[118:119], v[244:245] neg_lo:[0,1,0] neg_hi:[0,1,0]
    v_pk_fma_f32 v[246:247], v[134:135], v[118:119], v[246:247]
    v_cvt_pk_bf16_f32 v227, v244, v245
    v_cvt_pk_bf16_f32 v235, v246, v247
    v_pk_mul_f32 v[240:241], v[136:137], v[104:105]
    v_pk_mul_f32 v[242:243], v[152:153], v[104:105]
    v_pk_fma_f32 v[240:241], v[152:153], v[120:121], v[240:241] neg_lo:[0,1,0] neg_hi:[0,1,0]
    v_pk_fma_f32 v[242:243], v[136:137], v[120:121], v[242:243]
    v_cvt_pk_bf16_f32 v228, v240, v241
    v_cvt_pk_bf16_f32 v236, v242, v243
    v_pk_mul_f32 v[244:245], v[138:139], v[106:107]
    v_pk_mul_f32 v[246:247], v[154:155], v[106:107]
    v_pk_fma_f32 v[244:245], v[154:155], v[122:123], v[244:245] neg_lo:[0,1,0] neg_hi:[0,1,0]
    v_pk_fma_f32 v[246:247], v[138:139], v[122:123], v[246:247]
    v_cvt_pk_bf16_f32 v229, v244, v245
    v_cvt_pk_bf16_f32 v237, v246, v247
    v_pk_mul_f32 v[240:241], v[140:141], v[108:109]
    v_pk_mul_f32 v[242:243], v[156:157], v[108:109]
    v_pk_fma_f32 v[240:241], v[156:157], v[124:125], v[240:241] neg_lo:[0,1,0] neg_hi:[0,1,0]
    v_pk_fma_f32 v[242:243], v[140:141], v[124:125], v[242:243]
    v_cvt_pk_bf16_f32 v230, v240, v241
    v_cvt_pk_bf16_f32 v238, v242, v243
    v_pk_mul_f32 v[244:245], v[142:143], v[110:111]
    v_pk_mul_f32 v[246:247], v[158:159], v[110:111]
    v_pk_fma_f32 v[244:245], v[158:159], v[126:127], v[244:245] neg_lo:[0,1,0] neg_hi:[0,1,0]
    v_pk_fma_f32 v[246:247], v[142:143], v[126:127], v[246:247]
    v_cvt_pk_bf16_f32 v231, v244, v245
    v_cvt_pk_bf16_f32 v239, v246, v247
L_pse_11:
    s_cmp_lg_u32 s39, 0
    s_cbranch_scc1 L_i1s_12
    v_mfma_f32_32x32x16_bf16 v[128:143], v[224:227], a[0:3], 0
    v_lshlrev_b32 v24, 16, v200
    v_and_b32 v25, 0xffff0000, v200
    v_lshlrev_b32 v26, 16, v204
    v_and_b32 v27, 0xffff0000, v204
    v_add_f32 v176, v24, v26
    v_add_f32 v177, v25, v27
    v_mfma_f32_32x32x16_bf16 v[144:159], v[232:235], a[0:3], 0
    v_sub_f32 v184, v24, v26
    v_sub_f32 v185, v25, v27
    v_mul_f32 v176, v176, v248
    v_mul_f32 v177, v177, v249
    v_mul_f32 v184, v184, v252
    v_mul_f32 v185, v185, v253
    v_mfma_f32_32x32x16_bf16 v[128:143], v[232:235], a[16:19], v[128:143]
    v_lshlrev_b32 v24, 16, v201
    v_and_b32 v25, 0xffff0000, v201
    v_lshlrev_b32 v26, 16, v205
    v_and_b32 v27, 0xffff0000, v205
    v_add_f32 v178, v24, v26
    v_add_f32 v179, v25, v27
    v_mfma_f32_32x32x16_bf16 v[144:159], v[224:227], a[8:11], v[144:159]
    v_sub_f32 v186, v24, v26
    v_sub_f32 v187, v25, v27
    v_mul_f32 v178, v178, v250
    v_mul_f32 v179, v179, v251
    v_mul_f32 v186, v186, v254
    v_mul_f32 v187, v187, v255
    v_mfma_f32_32x32x16_bf16 v[128:143], v[228:231], a[4:7], v[128:143]
    v_lshlrev_b32 v24, 16, v202
    v_and_b32 v25, 0xffff0000, v202
    v_lshlrev_b32 v26, 16, v206
    v_and_b32 v27, 0xffff0000, v206
    v_add_f32 v180, v24, v26
    v_add_f32 v181, v25, v27
    v_mfma_f32_32x32x16_bf16 v[144:159], v[236:239], a[4:7], v[144:159]
    v_sub_f32 v188, v24, v26
    v_sub_f32 v189, v25, v27
    v_mul_f32 v180, v180, v248
    v_mul_f32 v181, v181, v249
    v_mul_f32 v188, v188, v252
    v_mul_f32 v189, v189, v253
    v_mfma_f32_32x32x16_bf16 v[128:143], v[236:239], a[20:23], v[128:143]
    v_lshlrev_b32 v24, 16, v203
    v_and_b32 v25, 0xffff0000, v203
    v_lshlrev_b32 v26, 16, v207
    v_and_b32 v27, 0xffff0000, v207
    v_add_f32 v182, v24, v26
    v_add_f32 v183, v25, v27
    v_mfma_f32_32x32x16_bf16 v[144:159], v[228:231], a[12:15], v[144:159]
    v_sub_f32 v190, v24, v26
    v_sub_f32 v191, v25, v27
    v_mul_f32 v182, v182, v250
    v_mul_f32 v183, v183, v251
    v_mul_f32 v190, v190, v254
    v_mul_f32 v191, v191, v255
    s_branch L_i1s_12_e
L_i1s_12:
    v_mfma_f32_32x32x16_bf16 v[128:143], v[224:227], a[0:3], 0
    s_nop 1
    v_mfma_f32_32x32x16_bf16 v[144:159], v[232:235], a[0:3], 0
    v_mfma_f32_32x32x16_bf16 v[128:143], v[232:235], a[16:19], v[128:143]
    v_mfma_f32_32x32x16_bf16 v[144:159], v[224:227], a[8:11], v[144:159]
    v_mfma_f32_32x32x16_bf16 v[128:143], v[228:231], a[4:7], v[128:143]
    v_mfma_f32_32x32x16_bf16 v[144:159], v[236:239], a[4:7], v[144:159]
    v_mfma_f32_32x32x16_bf16 v[128:143], v[236:239], a[20:23], v[128:143]
    v_mfma_f32_32x32x16_bf16 v[144:159], v[228:231], a[12:15], v[144:159]
L_i1s_12_e:
    v_mov_b32 v28, -1
    v_mov_b32 v29, -1
    v_mov_b32 v30, -1
    v_mov_b32 v31, -1
    s_add_u32 s47, s60, 4194304
    buffer_store_dwordx4 v[28:31], v6, s[12:15], s47 offen sc1
    s_add_u32 s47, s60, 4198400
    buffer_store_dwordx4 v[28:31], v6, s[12:15], s47 offen sc1
    s_add_u32 s47, s58, 20971520
    buffer_store_dwordx4 v[28:31], v6, s[12:15], s47 offen sc1
    s_add_u32 s47, s58, 20975616
    buffer_store_dwordx4 v[28:31], v6, s[12:15], s47 offen sc1
    v_pk_mul_f32 v[240:241], v[128:129], v[64:65]
    v_pk_mul_f32 v[242:243], v[144:145], v[64:65]
    v_pk_fma_f32 v[240:241], v[144:145], v[80:81], v[240:241] neg_lo:[0,1,0] neg_hi:[0,1,0]
    v_pk_fma_f32 v[242:243], v[128:129], v[80:81], v[242:243]
    v_cvt_pk_bf16_f32 v224, v240, v241
    v_cvt_pk_bf16_f32 v232, v242, v243
    v_pk_mul_f32 v[244:245], v[130:131], v[66:67]
    v_pk_mul_f32 v[246:247], v[146:147], v[66:67]
    v_pk_fma_f32 v[244:245], v[146:147], v[82:83], v[244:245] neg_lo:[0,1,0] neg_hi:[0,1,0]
    v_pk_fma_f32 v[246:247], v[130:131], v[82:83], v[246:247]
    v_cvt_pk_bf16_f32 v225, v244, v245
    v_cvt_pk_bf16_f32 v233, v246, v247
    v_pk_mul_f32 v[240:241], v[132:133], v[68:69]
    v_pk_mul_f32 v[242:243], v[148:149], v[68:69]
    v_pk_fma_f32 v[240:241], v[148:149], v[84:85], v[240:241] neg_lo:[0,1,0] neg_hi:[0,1,0]
    v_pk_fma_f32 v[242:243], v[132:133], v[84:85], v[242:243]
    v_cvt_pk_bf16_f32 v226, v240, v241
    v_cvt_pk_bf16_f32 v234, v242, v243
    v_pk_mul_f32 v[244:245], v[134:135], v[70:71]
    v_pk_mul_f32 v[246:247], v[150:151], v[70:71]
    v_pk_fma_f32 v[244:245], v[150:151], v[86:87], v[244:245] neg_lo:[0,1,0] neg_hi:[0,1,0]
    v_pk_fma_f32 v[246:247], v[134:135], v[86:87], v[246:247]
    v_cvt_pk_bf16_f32 v227, v244, v245
    v_cvt_pk_bf16_f32 v235, v246, v247
    v_pk_mul_f32 v[240:241], v[136:137], v[72:73]
    v_pk_mul_f32 v[242:243], v[152:153], v[72:73]
    v_pk_fma_f32 v[240:241], v[152:153], v[88:89], v[240:241] neg_lo:[0,1,0] neg_hi:[0,1,0]
    v_pk_fma_f32 v[242:243], v[136:137], v[88:89], v[242:243]
    v_cvt_pk_bf16_f32 v228, v240, v241
    v_cvt_pk_bf16_f32 v236, v242, v243
    v_pk_mul_f32 v[244:245], v[138:139], v[74:75]
    v_pk_mul_f32 v[246:247], v[154:155], v[74:75]
    v_pk_fma_f32 v[244:245], v[154:155], v[90:91], v[244:245] neg_lo:[0,1,0] neg_hi:[0,1,0]
    v_pk_fma_f32 v[246:247], v[138:139], v[90:91], v[246:247]
    v_cvt_pk_bf16_f32 v229, v244, v245
    v_cvt_pk_bf16_f32 v237, v246, v247
    v_pk_mul_f32 v[240:241], v[140:141], v[76:77]
    v_pk_mul_f32 v[242:243], v[156:157], v[76:77]
    v_pk_fma_f32 v[240:241], v[156:157], v[92:93], v[240:241] neg_lo:[0,1,0] neg_hi:[0,1,0]
    v_pk_fma_f32 v[242:243], v[140:141], v[92:93], v[242:243]
    v_cvt_pk_bf16_f32 v230, v240, v241
    v_cvt_pk_bf16_f32 v238, v242, v243
    v_pk_mul_f32 v[244:245], v[142:143], v[78:79]
    v_pk_mul_f32 v[246:247], v[158:159], v[78:79]
    v_pk_fma_f32 v[244:245], v[158:159], v[94:95], v[244:245] neg_lo:[0,1,0] neg_hi:[0,1,0]
    v_pk_fma_f32 v[246:247], v[142:143], v[94:95], v[246:247]
    v_cvt_pk_bf16_f32 v231, v244, v245
    v_cvt_pk_bf16_f32 v239, v246, v247
    v_mov_b32 v240, 0
    v_mov_b32 v241, 0
    v_mov_b32 v242, 0
    v_mov_b32 v243, 0
    v_mov_b32 v244, 0
    v_mov_b32 v245, 0
    v_mov_b32 v246, 0
    v_mov_b32 v247, 0
    v_pk_fma_f32 v[12:13], v[176:177], v[176:177], v[240:241] neg_lo:[0,0,1] neg_hi:[0,0,1]
    v_pk_fma_f32 v[12:13], v[180:181], v[180:181], v[12:13]
    v_pk_fma_f32 v[14:15], v[178:179], v[178:179], v[242:243] neg_lo:[0,0,1] neg_hi:[0,0,1]
    v_pk_fma_f32 v[14:15], v[182:183], v[182:183], v[14:15]
    v_pk_fma_f32 v[16:17], v[184:185], v[184:185], v[244:245] neg_lo:[0,0,1] neg_hi:[0,0,1]
    v_pk_fma_f32 v[16:17], v[188:189], v[188:189], v[16:17]
    v_pk_fma_f32 v[18:19], v[186:187], v[186:187], v[246:247] neg_lo:[0,0,1] neg_hi:[0,0,1]
    v_pk_fma_f32 v[18:19], v[190:191], v[190:191], v[18:19]
    s_cmp_eq_u32 s2, 0
    s_cbranch_scc1 L_ps_13
    v_pk_fma_f32 v[12:13], v[160:161], v[160:161], v[12:13]
    v_pk_fma_f32 v[12:13], v[164:165], v[164:165], v[12:13]
    v_pk_fma_f32 v[14:15], v[162:163], v[162:163], v[14:15]
    v_pk_fma_f32 v[14:15], v[166:167], v[166:167], v[14:15]
    v_pk_fma_f32 v[16:17], v[168:169], v[168:169], v[16:17]
    v_pk_fma_f32 v[16:17], v[172:173], v[172:173], v[16:17]
    v_pk_fma_f32 v[18:19], v[170:171], v[170:171], v[18:19]
    v_pk_fma_f32 v[18:19], v[174:175], v[174:175], v[18:19]
L_pe_14:
    s_cmp_lg_u32 s2, 0
    s_cbranch_scc1 L_m0_15
    v_accvgpr_read_b32 v160, a192
    v_accvgpr_read_b32 v168, a196
    v_accvgpr_read_b32 v161, a193
    v_accvgpr_read_b32 v169, a197
    v_accvgpr_read_b32 v162, a194
    v_accvgpr_read_b32 v170, a198
    v_accvgpr_read_b32 v163, a195
    v_accvgpr_read_b32 v171, a199
L_m0_15:
    v_accvgpr_write_b32 a96, v160
    v_accvgpr_write_b32 a97, v161
    v_accvgpr_write_b32 a98, v162
    v_accvgpr_write_b32 a99, v163
    v_accvgpr_write_b32 a100, v164
    v_accvgpr_write_b32 a101, v165
    v_accvgpr_write_b32 a102, v166
    v_accvgpr_write_b32 a103, v167
    v_accvgpr_write_b32 a104, v168
    v_accvgpr_write_b32 a105, v169
    v_accvgpr_write_b32 a106, v170
    v_accvgpr_write_b32 a107, v171
    v_accvgpr_write_b32 a108, v172
    v_accvgpr_write_b32 a109, v173
    v_accvgpr_write_b32 a110, v174
    v_accvgpr_write_b32 a111, v175
    v_accvgpr_write_b32 a112, v176
    v_accvgpr_write_b32 a113, v177
    v_accvgpr_write_b32 a114, v178
    v_accvgpr_write_b32 a115, v179
    v_accvgpr_write_b32 a116, v180
    v_accvgpr_write_b32 a117, v181
    v_accvgpr_write_b32 a118, v182
    v_accvgpr_write_b32 a119, v183
    v_accvgpr_write_b32 a120, v184
    v_accvgpr_write_b32 a121, v185
    v_accvgpr_write_b32 a122, v186
    v_accvgpr_write_b32 a123, v187
    v_accvgpr_write_b32 a124, v188
    v_accvgpr_write_b32 a125, v189
    v_accvgpr_write_b32 a126, v190
    v_accvgpr_write_b32 a127, v191
    v_mfma_f32_32x32x16_bf16 v[160:175], a[48:51], v[224:227], 0
    v_accvgpr_read_b32 v128, a96
    v_accvgpr_read_b32 v129, a97
    v_accvgpr_read_b32 v130, a98
    v_accvgpr_read_b32 v131, a99
    v_accvgpr_read_b32 v132, a100
    v_accvgpr_read_b32 v133, a101
    v_mfma_f32_32x32x16_bf16 v[160:175], a[64:67], v[232:235], v[160:175]
    v_accvgpr_read_b32 v134, a102
    v_accvgpr_read_b32 v135, a103
    v_accvgpr_read_b32 v136, a104
    v_accvgpr_read_b32 v137, a105
    v_accvgpr_read_b32 v138, a106
    v_accvgpr_read_b32 v139, a107
    v_mfma_f32_32x32x16_bf16 v[160:175], a[52:55], v[228:231], v[160:175]
    v_accvgpr_read_b32 v140, a108
    v_accvgpr_read_b32 v141, a109
    v_accvgpr_read_b32 v142, a110
    v_accvgpr_read_b32 v143, a111
    v_accvgpr_read_b32 v144, a112
    v_accvgpr_read_b32 v145, a113
    v_mfma_f32_32x32x16_bf16 v[160:175], a[68:71], v[236:239], v[160:175]
    v_accvgpr_read_b32 v146, a114
    v_accvgpr_read_b32 v147, a115
    v_accvgpr_read_b32 v148, a116
    v_accvgpr_read_b32 v149, a117
    v_accvgpr_read_b32 v150, a118
    v_accvgpr_read_b32 v151, a119
    v_mfma_f32_32x32x16_bf16 v[176:191], a[48:51], v[232:235], 0
    v_accvgpr_read_b32 v152, a120
    v_accvgpr_read_b32 v153, a121
    v_accvgpr_read_b32 v154, a122
    v_accvgpr_read_b32 v155, a123
    v_accvgpr_read_b32 v156, a124
    v_accvgpr_read_b32 v157, a125
    v_mfma_f32_32x32x16_bf16 v[176:191], a[56:59], v[224:227], v[176:191]
    v_accvgpr_read_b32 v158, a126
    v_accvgpr_read_b32 v159, a127
    s_lshl_b32 s41, s36, 13
    v_add_u32 v30, s41, v5
    v_add_u32_e64 v29, s61, v5
    v_mfma_f32_32x32x16_bf16 v[176:191], a[52:55], v[236:239], v[176:191]
    ds_write_b128 v30, v[160:163] offset:16384
    ds_write_b128 v30, v[164:167] offset:17408
    ds_write_b128 v30, v[168:171] offset:18432
    ds_write_b128 v30, v[172:175] offset:19456
    v_mfma_f32_32x32x16_bf16 v[176:191], a[60:63], v[228:231], v[176:191]
    s_nop 11
    s_nop 0
    ds_write_b128 v30, v[176:179] offset:20480
    ds_write_b128 v30, v[180:183] offset:21504
    ds_write_b128 v30, v[184:187] offset:22528
    ds_write_b128 v30, v[188:191] offset:23552
L_ar:
    s_waitcnt vmcnt(4) lgkmcnt(0)
    s_barrier
    ds_read_b128 v[96:99], v29 offset:16384
    ds_read_b128 v[104:107], v29 offset:24576
    ds_read_b128 v[100:103], v29 offset:20480
    ds_read_b128 v[108:111], v29 offset:28672
    ds_read_b128 v[112:115], v29 offset:32768
    ds_read_b128 v[120:123], v29 offset:40960
    ds_read_b128 v[116:119], v29 offset:36864
    ds_read_b128 v[124:127], v29 offset:45056
    s_waitcnt lgkmcnt(6)
    s_nop 0
    v_pk_add_f32 v[128:129], v[128:129], v[96:97]
    v_pk_add_f32 v[136:137], v[136:137], v[96:97]
    v_pk_add_f32 v[128:129], v[128:129], v[104:105]
    v_pk_add_f32 v[136:137], v[136:137], v[104:105] neg_lo:[0,1] neg_hi:[0,1]
    v_pk_add_f32 v[130:131], v[130:131], v[98:99]
    v_pk_add_f32 v[138:139], v[138:139], v[98:99]
    v_pk_add_f32 v[130:131], v[130:131], v[106:107]
    v_pk_add_f32 v[138:139], v[138:139], v[106:107] neg_lo:[0,1] neg_hi:[0,1]
    s_waitcnt lgkmcnt(4)
    s_nop 0
    v_pk_add_f32 v[132:133], v[132:133], v[100:101]
    v_pk_add_f32 v[140:141], v[140:141], v[100:101]
    v_pk_add_f32 v[132:133], v[132:133], v[108:109]
    v_pk_add_f32 v[140:141], v[140:141], v[108:109] neg_lo:[0,1] neg_hi:[0,1]
    v_pk_add_f32 v[134:135], v[134:135], v[102:103]
    v_pk_add_f32 v[142:143], v[142:143], v[102:103]
    v_pk_add_f32 v[134:135], v[134:135], v[110:111]
    v_pk_add_f32 v[142:143], v[142:143], v[110:111] neg_lo:[0,1] neg_hi:[0,1]
    s_waitcnt lgkmcnt(2)
    s_nop 0
    v_pk_add_f32 v[144:145], v[144:145], v[112:113]
    v_pk_add_f32 v[152:153], v[152:153], v[112:113]
    v_pk_add_f32 v[144:145], v[144:145], v[120:121]
    v_pk_add_f32 v[152:153], v[152:153], v[120:121] neg_lo:[0,1] neg_hi:[0,1]
    v_pk_add_f32 v[146:147], v[146:147], v[114:115]
    v_pk_add_f32 v[154:155], v[154:155], v[114:115]
    v_pk_add_f32 v[146:147], v[146:147], v[122:123]
    v_pk_add_f32 v[154:155], v[154:155], v[122:123] neg_lo:[0,1] neg_hi:[0,1]
    s_waitcnt lgkmcnt(0)
    s_nop 0
    v_pk_add_f32 v[148:149], v[148:149], v[116:117]
    v_pk_add_f32 v[156:157], v[156:157], v[116:117]
    v_pk_add_f32 v[148:149], v[148:149], v[124:125]
    v_pk_add_f32 v[156:157], v[156:157], v[124:125] neg_lo:[0,1] neg_hi:[0,1]
    v_pk_add_f32 v[150:151], v[150:151], v[118:119]
    v_pk_add_f32 v[158:159], v[158:159], v[118:119]
    v_pk_add_f32 v[150:151], v[150:151], v[126:127]
    v_pk_add_f32 v[158:159], v[158:159], v[126:127] neg_lo:[0,1] neg_hi:[0,1]
    v_pk_fma_f32 v[240:241], v[144:145], v[144:145], v[12:13] neg_lo:[0,0,1] neg_hi:[0,0,1]
    v_pk_fma_f32 v[240:241], v[148:149], v[148:149], v[240:241]
    v_pk_fma_f32 v[242:243], v[146:147], v[146:147], v[14:15] neg_lo:[0,0,1] neg_hi:[0,0,1]
    v_pk_fma_f32 v[242:243], v[150:151], v[150:151], v[242:243]
    v_pk_fma_f32 v[244:245], v[152:153], v[152:153], v[16:17] neg_lo:[0,0,1] neg_hi:[0,0,1]
    v_pk_fma_f32 v[244:245], v[156:157], v[156:157], v[244:245]
    v_pk_fma_f32 v[246:247], v[154:155], v[154:155], v[18:19] neg_lo:[0,0,1] neg_hi:[0,0,1]
    v_pk_fma_f32 v[246:247], v[158:159], v[158:159], v[246:247]
    s_cmp_eq_u32 s2, 0
    s_cbranch_scc1 L_ps_16
    v_pk_fma_f32 v[240:241], v[128:129], v[128:129], v[240:241]
    v_pk_fma_f32 v[240:241], v[132:133], v[132:133], v[240:241]
    v_pk_fma_f32 v[242:243], v[130:131], v[130:131], v[242:243]
    v_pk_fma_f32 v[242:243], v[134:135], v[134:135], v[242:243]
    v_pk_fma_f32 v[244:245], v[136:137], v[136:137], v[244:245]
    v_pk_fma_f32 v[244:245], v[140:141], v[140:141], v[244:245]
    v_pk_fma_f32 v[246:247], v[138:139], v[138:139], v[246:247]
    v_pk_fma_f32 v[246:247], v[142:143], v[142:143], v[246:247]
L_pe_17:
    s_add_u32 s47, s64, 1048576
    v_min_u32 v243, -2, v243
    v_min_u32 v247, -2, v247
    s_waitcnt vmcnt(0)
    buffer_store_dwordx4 v[240:243], v9, s[12:15], s64 offen sc1
    buffer_store_dwordx4 v[244:247], v9, s[12:15], s47 offen sc1
    s_cmp_lg_u32 s2, 0
    s_cbranch_scc1 L_w1_18
    s_nop 0
    s_mov_b32 s52, 0x3a800000
    s_mov_b32 s53, 0xc4800000
    v_pk_mul_f32 v[224:225], v[128:129], s[52:53] op_sel_hi:[1,0]
    v_cvt_pk_bf16_f32 v225, v224, v225
    v_lshlrev_b32_e64 v224, 16, v225
    v_and_b32 v225, 0xffff0000, v225
    v_pk_fma_f32 v[128:129], v[224:225], s[52:53], v[128:129] op_sel:[0,1,0] op_sel_hi:[1,1,1]
    v_pk_mul_f32 v[224:225], v[130:131], s[52:53] op_sel_hi:[1,0]
    v_cvt_pk_bf16_f32 v225, v224, v225
    v_lshlrev_b32_e64 v224, 16, v225
    v_and_b32 v225, 0xffff0000, v225
    v_pk_fma_f32 v[130:131], v[224:225], s[52:53], v[130:131] op_sel:[0,1,0] op_sel_hi:[1,1,1]
    v_pk_mul_f32 v[224:225], v[136:137], s[52:53] op_sel_hi:[1,0]
    v_cvt_pk_bf16_f32 v225, v224, v225
    v_lshlrev_b32_e64 v224, 16, v225
    v_and_b32 v225, 0xffff0000, v225
    v_pk_fma_f32 v[136:137], v[224:225], s[52:53], v[136:137] op_sel:[0,1,0] op_sel_hi:[1,1,1]
    v_pk_mul_f32 v[224:225], v[138:139], s[52:53] op_sel_hi:[1,0]
    v_cvt_pk_bf16_f32 v225, v224, v225
    v_lshlrev_b32_e64 v224, 16, v225
    v_and_b32 v225, 0xffff0000, v225
    v_pk_fma_f32 v[138:139], v[224:225], s[52:53], v[138:139] op_sel:[0,1,0] op_sel_hi:[1,1,1]
L_w1_18:
    s_waitcnt vmcnt(0)
    s_cmp_eq_u32 s40, 0
    s_cbranch_scc1 L_w1_18_n
    s_cmp_eq_u32 s40, 2
    s_cbranch_scc1 L_w1_18_b
    s_nop 0
    v_accvgpr_read_b32 v112, a128
    v_accvgpr_read_b32 v208, a160
    v_accvgpr_read_b32 v113, a129
    v_accvgpr_read_b32 v209, a161
    v_accvgpr_read_b32 v114, a130
    v_accvgpr_read_b32 v210, a162
    v_accvgpr_read_b32 v115, a131
    v_accvgpr_read_b32 v211, a163
    v_accvgpr_read_b32 v116, a132
    v_accvgpr_read_b32 v212, a164
    v_accvgpr_read_b32 v117, a133
    v_accvgpr_read_b32 v213, a165
    v_accvgpr_read_b32 v118, a134
    v_accvgpr_read_b32 v214, a166
    v_accvgpr_read_b32 v119, a135
    v_accvgpr_read_b32 v215, a167
    v_accvgpr_read_b32 v120, a136
    v_accvgpr_read_b32 v216, a168
    v_accvgpr_read_b32 v121, a137
    v_accvgpr_read_b32 v217, a169
    v_accvgpr_read_b32 v122, a138
    v_accvgpr_read_b32 v218, a170
    v_accvgpr_read_b32 v123, a139
    v_accvgpr_read_b32 v219, a171
    v_accvgpr_read_b32 v124, a140
    v_accvgpr_read_b32 v220, a172
    v_accvgpr_read_b32 v125, a141
    v_accvgpr_read_b32 v221, a173
    v_accvgpr_read_b32 v126, a142
    v_accvgpr_read_b32 v222, a174
    v_accvgpr_read_b32 v127, a143
    v_accvgpr_read_b32 v223, a175
    s_branch L_w1_18_n
L_w1_18_b:
    s_nop 0
    v_accvgpr_read_b32 v112, a144
    v_accvgpr_read_b32 v208, a176
    v_accvgpr_read_b32 v113, a145
    v_accvgpr_read_b32 v209, a177
    v_accvgpr_read_b32 v114, a146
    v_accvgpr_read_b32 v210, a178
    v_accvgpr_read_b32 v115, a147
    v_accvgpr_read_b32 v211, a179
    v_accvgpr_read_b32 v116, a148
    v_accvgpr_read_b32 v212, a180
    v_accvgpr_read_b32 v117, a149
    v_accvgpr_read_b32 v213, a181
    v_accvgpr_read_b32 v118, a150
    v_accvgpr_read_b32 v214, a182
    v_accvgpr_read_b32 v119, a151
    v_accvgpr_read_b32 v215, a183
    v_accvgpr_read_b32 v120, a152
    v_accvgpr_read_b32 v216, a184
    v_accvgpr_read_b32 v121, a153
    v_accvgpr_read_b32 v217, a185
    v_accvgpr_read_b32 v122, a154
    v_accvgpr_read_b32 v218, a186
    v_accvgpr_read_b32 v123, a155
    v_accvgpr_read_b32 v219, a187
    v_accvgpr_read_b32 v124, a156
    v_accvgpr_read_b32 v220, a188
    v_accvgpr_read_b32 v125, a157
    v_accvgpr_read_b32 v221, a189
    v_accvgpr_read_b32 v126, a158
    v_accvgpr_read_b32 v222, a190
    v_accvgpr_read_b32 v127, a159
    v_accvgpr_read_b32 v223, a191
L_w1_18_n:
    s_mov_b32 s90, s65
    s_add_u32 s91, s65, 4096
    s_add_u32 s92, s65, 8192
    s_add_u32 s93, s65, 12288
    v_and_b32 v30, 3, v1
    v_lshlrev_b32_e64 v30, 2, v30
    v_bfe_u32 v29, v1, 4, 1
    v_lshl_add_u32 v30, v29, 1, v30
    v_add_u32 v30, v30, v3
    v_lshlrev_b32 v30, 4, v30
    s_lshl_b32 s41, s36, 2
    s_add_u32 s41, s41, 49408
    v_add_u32 v30, s41, v30
    v_and_b32 v28, 15, v1
    v_lshlrev_b32 v29, 4, v28
    v_lshrrev_b32 v27, 4, v1
    v_lshlrev_b32 v27, 13, v27
    v_lshl_add_u32 v28, v28, 2, v27
    s_add_u32 s53, s67, 4096
    v_mov_b32 v27, 0x36000000
    s_mov_b32 s46, 0
L_pb_19:
    s_nop 0
    buffer_load_dwordx4 v[224:227], v6, s[12:15], s90 offen offset:0 sc1
    buffer_load_dwordx4 v[228:231], v6, s[12:15], s91 offen offset:0 sc1
    buffer_load_dwordx4 v[232:235], v6, s[12:15], s92 offen offset:0 sc1
    buffer_load_dwordx4 v[236:239], v6, s[12:15], s93 offen offset:0 sc1
    s_waitcnt vmcnt(0)
    v_max_u32 v31, v227, v231
    v_max3_u32 v31, v31, v235, v239
    v_cmp_eq_u32 vcc, -1, v31
    s_nop 0
    s_cbranch_vccnz L_pb_19_s
    s_mov_b64 exec, -1
    v_pk_add_f32 v[224:225], v[224:225], v[228:229]
    v_pk_add_f32 v[232:233], v[232:233], v[236:237]
    v_pk_add_f32 v[226:227], v[226:227], v[230:231]
    v_pk_add_f32 v[234:235], v[234:235], v[238:239]
    v_pk_add_f32 v[224:225], v[224:225], v[232:233]
    v_pk_add_f32 v[226:227], v[226:227], v[234:235]
    s_nop 0
    v_permlane32_swap_b32 v224, v225
    v_permlane32_swap_b32 v226, v227
    v_add_f32 v224, v224, v225
    v_add_f32 v226, v226, v227
    s_nop 1
    v_permlane16_swap_b32 v224, v226
    v_add_f32 v224, v224, v226
    s_nop 1
    v_add_f32_dpp v224, v224, v224 row_ror:8 row_mask:0xf bank_mask:0xf
    s_nop 1
    v_add_f32_dpp v224, v224, v224 row_ror:4 row_mask:0xf bank_mask:0xf
    ds_write_b32 v30, v224
    s_waitcnt lgkmcnt(0)
    s_barrier
    s_cmp_lg_u32 s36, 3
    s_cbranch_scc1 L_red2_20
    ds_read_b128 v[224:227], v29 offset:49408
    s_waitcnt lgkmcnt(0)
    v_pk_add_f32 v[224:225], v[224:225], v[226:227]
    v_add_f32 v224, v224, v225
    v_fma_f32 v224, v224, v27, v23
    v_max_f32_e64 v224, 0, v224
    v_cvt_pk_bf16_f32 v224, v224, v224
    v_and_b32 v224, 0xffff0000, v224
    v_add_f32 v224, 0x3727c5ac, v224
    v_cvt_pk_bf16_f32 v224, v224, v224
    v_and_b32 v224, 0xffff0000, v224
    v_sqrt_f32 v224, v224
    s_nop 0
    v_cvt_pk_bf16_f32 v224, v224, v224
    v_and_b32 v224, 0xffff0000, v224
    v_rcp_f32 v224, v224
    s_nop 0
    v_min_u32 v224, -2, v224
    buffer_store_dword v224, v28, s[12:15], s66 offen sc1
L_red2_20:
    s_cmp_lg_u32 s40, 0
    s_cbranch_scc1 L_wbx_21
    s_nop 0
    s_add_u32 s42, s63, 33554432
    s_add_u32 s43, s42, 4194304
    buffer_load_dwordx4 v[112:115], v5, s[12:15], s42 offen offset:0 sc1
    buffer_load_dwordx4 v[116:119], v5, s[12:15], s42 offen offset:1024 sc1
    buffer_load_dwordx4 v[120:123], v5, s[12:15], s42 offen offset:2048 sc1
    buffer_load_dwordx4 v[124:127], v5, s[12:15], s42 offen offset:3072 sc1
    s_cmp_eq_u32 s39, 0
    s_cbranch_scc1 L_wbx_21_a
    buffer_load_dwordx4 v[208:211], v5, s[12:15], s43 offen offset:0 sc1
    buffer_load_dwordx4 v[212:215], v5, s[12:15], s43 offen offset:1024 sc1
    buffer_load_dwordx4 v[216:219], v5, s[12:15], s43 offen offset:2048 sc1
    buffer_load_dwordx4 v[220:223], v5, s[12:15], s43 offen offset:3072 sc1
L_wbx_21_a:
    s_waitcnt vmcnt(0)
    s_nop 0
    v_accvgpr_write_b32 a144, v112
    v_accvgpr_write_b32 a176, v208
    v_accvgpr_write_b32 a145, v113
    v_accvgpr_write_b32 a177, v209
    v_accvgpr_write_b32 a146, v114
    v_accvgpr_write_b32 a178, v210
    v_accvgpr_write_b32 a147, v115
    v_accvgpr_write_b32 a179, v211
    v_accvgpr_write_b32 a148, v116
    v_accvgpr_write_b32 a180, v212
    v_accvgpr_write_b32 a149, v117
    v_accvgpr_write_b32 a181, v213
    v_accvgpr_write_b32 a150, v118
    v_accvgpr_write_b32 a182, v214
    v_accvgpr_write_b32 a151, v119
    v_accvgpr_write_b32 a183, v215
    v_accvgpr_write_b32 a152, v120
    v_accvgpr_write_b32 a184, v216
    v_accvgpr_write_b32 a153, v121
    v_accvgpr_write_b32 a185, v217
    v_accvgpr_write_b32 a154, v122
    v_accvgpr_write_b32 a186, v218
    v_accvgpr_write_b32 a155, v123
    v_accvgpr_write_b32 a187, v219
    v_accvgpr_write_b32 a156, v124
    v_accvgpr_write_b32 a188, v220
    v_accvgpr_write_b32 a157, v125
    v_accvgpr_write_b32 a189, v221
    v_accvgpr_write_b32 a158, v126
    v_accvgpr_write_b32 a190, v222
    v_accvgpr_write_b32 a159, v127
    v_accvgpr_write_b32 a191, v223
L_wbx_21:
    s_cmp_eq_u32 s39, 0
    s_cbranch_scc1 L_wbx_21_b
    v_lshlrev_b32 v96, 16, v112
    v_and_b32 v112, 0xffff0000, v112
    v_lshlrev_b32 v97, 16, v113
    v_and_b32 v113, 0xffff0000, v113
    v_lshlrev_b32 v98, 16, v114
    v_and_b32 v114, 0xffff0000, v114
    v_lshlrev_b32 v99, 16, v115
    v_and_b32 v115, 0xffff0000, v115
    v_lshlrev_b32 v100, 16, v116
    v_and_b32 v116, 0xffff0000, v116
    v_lshlrev_b32 v101, 16, v117
    v_and_b32 v117, 0xffff0000, v117
    v_lshlrev_b32 v102, 16, v118
    v_and_b32 v118, 0xffff0000, v118
    v_lshlrev_b32 v103, 16, v119
    v_and_b32 v119, 0xffff0000, v119
    v_lshlrev_b32 v104, 16, v120
    v_and_b32 v120, 0xffff0000, v120
    v_lshlrev_b32 v105, 16, v121
    v_and_b32 v121, 0xffff0000, v121
    v_lshlrev_b32 v106, 16, v122
    v_and_b32 v122, 0xffff0000, v122
    v_lshlrev_b32 v107, 16, v123
    v_and_b32 v123, 0xffff0000, v123
    v_lshlrev_b32 v108, 16, v124
    v_and_b32 v124, 0xffff0000, v124
    v_lshlrev_b32 v109, 16, v125
    v_and_b32 v125, 0xffff0000, v125
    v_lshlrev_b32 v110, 16, v126
    v_and_b32 v126, 0xffff0000, v126
    v_lshlrev_b32 v111, 16, v127
    v_and_b32 v127, 0xffff0000, v127
    v_lshlrev_b32 v192, 16, v208
    v_and_b32 v208, 0xffff0000, v208
    v_lshlrev_b32 v193, 16, v209
    v_and_b32 v209, 0xffff0000, v209
    v_lshlrev_b32 v194, 16, v210
    v_and_b32 v210, 0xffff0000, v210
    v_lshlrev_b32 v195, 16, v211
    v_and_b32 v211, 0xffff0000, v211
    v_lshlrev_b32 v196, 16, v212
    v_and_b32 v212, 0xffff0000, v212
    v_lshlrev_b32 v197, 16, v213
    v_and_b32 v213, 0xffff0000, v213
    v_lshlrev_b32 v198, 16, v214
    v_and_b32 v214, 0xffff0000, v214
    v_lshlrev_b32 v199, 16, v215
    v_and_b32 v215, 0xffff0000, v215
    v_lshlrev_b32 v200, 16, v216
    v_and_b32 v216, 0xffff0000, v216
    v_lshlrev_b32 v201, 16, v217
    v_and_b32 v217, 0xffff0000, v217
    v_lshlrev_b32 v202, 16, v218
    v_and_b32 v218, 0xffff0000, v218
    v_lshlrev_b32 v203, 16, v219
    v_and_b32 v219, 0xffff0000, v219
    v_lshlrev_b32 v204, 16, v220
    v_and_b32 v220, 0xffff0000, v220
    v_lshlrev_b32 v205, 16, v221
    v_and_b32 v221, 0xffff0000, v221
    v_lshlrev_b32 v206, 16, v222
    v_and_b32 v222, 0xffff0000, v222
    v_lshlrev_b32 v207, 16, v223
    v_and_b32 v223, 0xffff0000, v223
    v_pk_add_f32 v[192:193], v[96:97], v[192:193] neg_lo:[0,1] neg_hi:[0,1]
    v_pk_fma_f32 v[96:97], v[96:97], 2.0, v[192:193] op_sel_hi:[1,0,1] neg_lo:[0,0,1] neg_hi:[0,0,1]
    v_pk_add_f32 v[194:195], v[98:99], v[194:195] neg_lo:[0,1] neg_hi:[0,1]
    v_pk_fma_f32 v[98:99], v[98:99], 2.0, v[194:195] op_sel_hi:[1,0,1] neg_lo:[0,0,1] neg_hi:[0,0,1]
    v_pk_add_f32 v[196:197], v[100:101], v[196:197] neg_lo:[0,1] neg_hi:[0,1]
    v_pk_fma_f32 v[100:101], v[100:101], 2.0, v[196:197] op_sel_hi:[1,0,1] neg_lo:[0,0,1] neg_hi:[0,0,1]
    v_pk_add_f32 v[198:199], v[102:103], v[198:199] neg_lo:[0,1] neg_hi:[0,1]
    v_pk_fma_f32 v[102:103], v[102:103], 2.0, v[198:199] op_sel_hi:[1,0,1] neg_lo:[0,0,1] neg_hi:[0,0,1]
    v_pk_add_f32 v[200:201], v[104:105], v[200:201] neg_lo:[0,1] neg_hi:[0,1]
    v_pk_fma_f32 v[104:105], v[104:105], 2.0, v[200:201] op_sel_hi:[1,0,1] neg_lo:[0,0,1] neg_hi:[0,0,1]
    v_pk_add_f32 v[202:203], v[106:107], v[202:203] neg_lo:[0,1] neg_hi:[0,1]
    v_pk_fma_f32 v[106:107], v[106:107], 2.0, v[202:203] op_sel_hi:[1,0,1] neg_lo:[0,0,1] neg_hi:[0,0,1]
    v_pk_add_f32 v[204:205], v[108:109], v[204:205] neg_lo:[0,1] neg_hi:[0,1]
    v_pk_fma_f32 v[108:109], v[108:109], 2.0, v[204:205] op_sel_hi:[1,0,1] neg_lo:[0,0,1] neg_hi:[0,0,1]
    v_pk_add_f32 v[206:207], v[110:111], v[206:207] neg_lo:[0,1] neg_hi:[0,1]
    v_pk_fma_f32 v[110:111], v[110:111], 2.0, v[206:207] op_sel_hi:[1,0,1] neg_lo:[0,0,1] neg_hi:[0,0,1]
    v_pk_add_f32 v[208:209], v[112:113], v[208:209] neg_lo:[0,1] neg_hi:[0,1]
    v_pk_fma_f32 v[112:113], v[112:113], 2.0, v[208:209] op_sel_hi:[1,0,1] neg_lo:[0,0,1] neg_hi:[0,0,1]
    v_pk_add_f32 v[210:211], v[114:115], v[210:211] neg_lo:[0,1] neg_hi:[0,1]
    v_pk_fma_f32 v[114:115], v[114:115], 2.0, v[210:211] op_sel_hi:[1,0,1] neg_lo:[0,0,1] neg_hi:[0,0,1]
    v_pk_add_f32 v[212:213], v[116:117], v[212:213] neg_lo:[0,1] neg_hi:[0,1]
    v_pk_fma_f32 v[116:117], v[116:117], 2.0, v[212:213] op_sel_hi:[1,0,1] neg_lo:[0,0,1] neg_hi:[0,0,1]
    v_pk_add_f32 v[214:215], v[118:119], v[214:215] neg_lo:[0,1] neg_hi:[0,1]
    v_pk_fma_f32 v[118:119], v[118:119], 2.0, v[214:215] op_sel_hi:[1,0,1] neg_lo:[0,0,1] neg_hi:[0,0,1]
    v_pk_add_f32 v[216:217], v[120:121], v[216:217] neg_lo:[0,1] neg_hi:[0,1]
    v_pk_fma_f32 v[120:121], v[120:121], 2.0, v[216:217] op_sel_hi:[1,0,1] neg_lo:[0,0,1] neg_hi:[0,0,1]
    v_pk_add_f32 v[218:219], v[122:123], v[218:219] neg_lo:[0,1] neg_hi:[0,1]
    v_pk_fma_f32 v[122:123], v[122:123], 2.0, v[218:219] op_sel_hi:[1,0,1] neg_lo:[0,0,1] neg_hi:[0,0,1]
    v_pk_add_f32 v[220:221], v[124:125], v[220:221] neg_lo:[0,1] neg_hi:[0,1]
    v_pk_fma_f32 v[124:125], v[124:125], 2.0, v[220:221] op_sel_hi:[1,0,1] neg_lo:[0,0,1] neg_hi:[0,0,1]
    v_pk_add_f32 v[222:223], v[126:127], v[222:223] neg_lo:[0,1] neg_hi:[0,1]
    v_pk_fma_f32 v[126:127], v[126:127], 2.0, v[222:223] op_sel_hi:[1,0,1] neg_lo:[0,0,1] neg_hi:[0,0,1]
L_wbx_21_b:
    s_add_u32 s64, s64, 0x200000
    s_add_u32 s65, s65, 0x200000
    s_add_u32 s66, s66, 65536
    s_mov_b32 s52, s67
    s_add_u32 s67, s67, 65536
    s_waitcnt vmcnt(0)
    s_barrier
    s_cmp_lg_u32 s39, 0
    s_cbranch_scc1 L_wbx_21_c
    v_lshlrev_b32 v96, 16, v112
    v_and_b32 v112, 0xffff0000, v112
    v_lshlrev_b32 v97, 16, v113
    v_and_b32 v113, 0xffff0000, v113
    v_lshlrev_b32 v98, 16, v114
    v_and_b32 v114, 0xffff0000, v114
    v_lshlrev_b32 v99, 16, v115
    v_and_b32 v115, 0xffff0000, v115
    v_lshlrev_b32 v100, 16, v116
    v_and_b32 v116, 0xffff0000, v116
    v_lshlrev_b32 v101, 16, v117
    v_and_b32 v117, 0xffff0000, v117
    v_lshlrev_b32 v102, 16, v118
    v_and_b32 v118, 0xffff0000, v118
    v_lshlrev_b32 v103, 16, v119
    v_and_b32 v119, 0xffff0000, v119
    v_lshlrev_b32 v104, 16, v120
    v_and_b32 v120, 0xffff0000, v120
    v_lshlrev_b32 v105, 16, v121
    v_and_b32 v121, 0xffff0000, v121
    v_lshlrev_b32 v106, 16, v122
    v_and_b32 v122, 0xffff0000, v122
    v_lshlrev_b32 v107, 16, v123
    v_and_b32 v123, 0xffff0000, v123
    v_lshlrev_b32 v108, 16, v124
    v_and_b32 v124, 0xffff0000, v124
    v_lshlrev_b32 v109, 16, v125
    v_and_b32 v125, 0xffff0000, v125
    v_lshlrev_b32 v110, 16, v126
    v_and_b32 v126, 0xffff0000, v126
    v_lshlrev_b32 v111, 16, v127
    v_and_b32 v127, 0xffff0000, v127
L_wbx_21_c:
    s_mov_b32 s46, 0
L_pb_22:
    buffer_load_dwordx4 v[248:251], v5, s[12:15], s52 offen offset:0 sc1
    buffer_load_dwordx4 v[252:255], v5, s[12:15], s53 offen offset:0 sc1
    s_waitcnt vmcnt(0)
    v_max_u32 v31, v248, v249
    v_max3_u32 v31, v31, v250, v251
    v_max3_u32 v31, v31, v252, v253
    v_max3_u32 v31, v31, v254, v255
    v_cmp_eq_u32 vcc, -1, v31
    s_nop 0
    s_cbranch_vccnz L_pb_22_s
    s_mov_b64 exec, -1
    v_pk_mul_f32 v[128:129], v[128:129], v[248:249]
    v_pk_fma_f32 v[240:241], v[136:137], v[252:253], v[128:129]
    v_pk_fma_f32 v[242:243], v[136:137], v[252:253], v[128:129] neg_lo:[0,1,0] neg_hi:[0,1,0]
    v_cvt_pk_bf16_f32 v224, v240, v241
    v_cvt_pk_bf16_f32 v226, v242, v243
    v_pk_mul_f32 v[130:131], v[130:131], v[250:251]
    v_pk_fma_f32 v[244:245], v[138:139], v[254:255], v[130:131]
    v_pk_fma_f32 v[246:247], v[138:139], v[254:255], v[130:131] neg_lo:[0,1,0] neg_hi:[0,1,0]
    v_cvt_pk_bf16_f32 v225, v244, v245
    v_cvt_pk_bf16_f32 v227, v246, v247
    ds_write_b64 v11, v[224:225] offset:0
    ds_write_b64 v11, v[226:227] offset:4096
    v_pk_mul_f32 v[132:133], v[132:133], v[248:249]
    v_pk_fma_f32 v[240:241], v[140:141], v[252:253], v[132:133]
    v_pk_fma_f32 v[242:243], v[140:141], v[252:253], v[132:133] neg_lo:[0,1,0] neg_hi:[0,1,0]
    v_cvt_pk_bf16_f32 v228, v240, v241
    v_cvt_pk_bf16_f32 v230, v242, v243
    v_pk_mul_f32 v[134:135], v[134:135], v[250:251]
    v_pk_fma_f32 v[244:245], v[142:143], v[254:255], v[134:135]
    v_pk_fma_f32 v[246:247], v[142:143], v[254:255], v[134:135] neg_lo:[0,1,0] neg_hi:[0,1,0]
    v_cvt_pk_bf16_f32 v229, v244, v245
    v_cvt_pk_bf16_f32 v231, v246, v247
    ds_write_b64 v11, v[228:229] offset:2048
    ds_write_b64 v11, v[230:231] offset:6144
    v_pk_mul_f32 v[144:145], v[144:145], v[248:249]
    v_pk_fma_f32 v[240:241], v[152:153], v[252:253], v[144:145]
    v_pk_fma_f32 v[242:243], v[152:153], v[252:253], v[144:145] neg_lo:[0,1,0] neg_hi:[0,1,0]
    v_cvt_pk_bf16_f32 v232, v240, v241
    v_cvt_pk_bf16_f32 v234, v242, v243
    v_pk_mul_f32 v[146:147], v[146:147], v[250:251]
    v_pk_fma_f32 v[244:245], v[154:155], v[254:255], v[146:147]
    v_pk_fma_f32 v[246:247], v[154:155], v[254:255], v[146:147] neg_lo:[0,1,0] neg_hi:[0,1,0]
    v_cvt_pk_bf16_f32 v233, v244, v245
    v_cvt_pk_bf16_f32 v235, v246, v247
    ds_write_b64 v11, v[232:233] offset:8192
    ds_write_b64 v11, v[234:235] offset:12288
    v_pk_mul_f32 v[148:149], v[148:149], v[248:249]
    v_pk_fma_f32 v[240:241], v[156:157], v[252:253], v[148:149]
    v_pk_fma_f32 v[242:243], v[156:157], v[252:253], v[148:149] neg_lo:[0,1,0] neg_hi:[0,1,0]
    v_cvt_pk_bf16_f32 v236, v240, v241
    v_cvt_pk_bf16_f32 v238, v242, v243
    v_pk_mul_f32 v[150:151], v[150:151], v[250:251]
    v_pk_fma_f32 v[244:245], v[158:159], v[254:255], v[150:151]
    v_pk_fma_f32 v[246:247], v[158:159], v[254:255], v[150:151] neg_lo:[0,1,0] neg_hi:[0,1,0]
    v_cvt_pk_bf16_f32 v237, v244, v245
    v_cvt_pk_bf16_f32 v239, v246, v247
    ds_write_b64 v11, v[236:237] offset:10240
    ds_write_b64 v11, v[238:239] offset:14336
    s_add_u32 s40, s40, 1
    s_waitcnt lgkmcnt(0)
    s_barrier
    s_nop 0
    ds_read_b128 v[224:227], v10 offset:0
    ds_read_b128 v[232:235], v10 offset:2048
    ds_read_b128 v[228:231], v10 offset:1024
    ds_read_b128 v[236:239], v10 offset:3072
    s_waitcnt lgkmcnt(2)
    s_nop 0
    v_mfma_f32_32x32x16_bf16 v[128:143], v[224:227], a[24:27], 0
    v_mfma_f32_32x32x16_bf16 v[144:159], v[232:235], a[24:27], 0
    v_mfma_f32_32x32x16_bf16 v[128:143], v[232:235], a[32:35], v[128:143]
    v_mfma_f32_32x32x16_bf16 v[144:159], v[224:227], a[40:43], v[144:159]
    s_waitcnt lgkmcnt(0)
    s_nop 0
    v_mfma_f32_32x32x16_bf16 v[128:143], v[228:231], a[28:31], v[128:143]
    v_mfma_f32_32x32x16_bf16 v[144:159], v[236:239], a[28:31], v[144:159]
    v_mfma_f32_32x32x16_bf16 v[128:143], v[236:239], a[36:39], v[128:143]
    v_mfma_f32_32x32x16_bf16 v[144:159], v[228:231], a[44:47], v[144:159]
    s_nop 10
    s_nop 0
    v_pk_mul_f32 v[240:241], v[128:129], v[32:33]
    v_pk_mul_f32 v[242:243], v[144:145], v[32:33]
    v_pk_fma_f32 v[240:241], v[144:145], v[48:49], v[240:241]
    v_pk_fma_f32 v[242:243], v[128:129], v[48:49], v[242:243] neg_lo:[0,1,0] neg_hi:[0,1,0]
    v_cvt_pk_bf16_f32 v224, v240, v241
    v_cvt_pk_bf16_f32 v232, v242, v243
    v_pk_mul_f32 v[244:245], v[130:131], v[34:35]
    v_pk_mul_f32 v[246:247], v[146:147], v[34:35]
    v_pk_fma_f32 v[244:245], v[146:147], v[50:51], v[244:245]
    v_pk_fma_f32 v[246:247], v[130:131], v[50:51], v[246:247] neg_lo:[0,1,0] neg_hi:[0,1,0]
    v_cvt_pk_bf16_f32 v225, v244, v245
    v_cvt_pk_bf16_f32 v233, v246, v247
    v_pk_mul_f32 v[240:241], v[132:133], v[36:37]
    v_pk_mul_f32 v[242:243], v[148:149], v[36:37]
    v_pk_fma_f32 v[240:241], v[148:149], v[52:53], v[240:241]
    v_pk_fma_f32 v[242:243], v[132:133], v[52:53], v[242:243] neg_lo:[0,1,0] neg_hi:[0,1,0]
    v_cvt_pk_bf16_f32 v226, v240, v241
    v_cvt_pk_bf16_f32 v234, v242, v243
    v_pk_mul_f32 v[244:245], v[134:135], v[38:39]
    v_pk_mul_f32 v[246:247], v[150:151], v[38:39]
    v_pk_fma_f32 v[244:245], v[150:151], v[54:55], v[244:245]
    v_pk_fma_f32 v[246:247], v[134:135], v[54:55], v[246:247] neg_lo:[0,1,0] neg_hi:[0,1,0]
    v_cvt_pk_bf16_f32 v227, v244, v245
    v_cvt_pk_bf16_f32 v235, v246, v247
    v_pk_mul_f32 v[240:241], v[136:137], v[40:41]
    v_pk_mul_f32 v[242:243], v[152:153], v[40:41]
    v_pk_fma_f32 v[240:241], v[152:153], v[56:57], v[240:241]
    v_pk_fma_f32 v[242:243], v[136:137], v[56:57], v[242:243] neg_lo:[0,1,0] neg_hi:[0,1,0]
    v_cvt_pk_bf16_f32 v228, v240, v241
    v_cvt_pk_bf16_f32 v236, v242, v243
    v_pk_mul_f32 v[244:245], v[138:139], v[42:43]
    v_pk_mul_f32 v[246:247], v[154:155], v[42:43]
    v_pk_fma_f32 v[244:245], v[154:155], v[58:59], v[244:245]
    v_pk_fma_f32 v[246:247], v[138:139], v[58:59], v[246:247] neg_lo:[0,1,0] neg_hi:[0,1,0]
    v_cvt_pk_bf16_f32 v229, v244, v245
    v_cvt_pk_bf16_f32 v237, v246, v247
    v_pk_mul_f32 v[240:241], v[140:141], v[44:45]
    v_pk_mul_f32 v[242:243], v[156:157], v[44:45]
    v_pk_fma_f32 v[240:241], v[156:157], v[60:61], v[240:241]
    v_pk_fma_f32 v[242:243], v[140:141], v[60:61], v[242:243] neg_lo:[0,1,0] neg_hi:[0,1,0]
    v_cvt_pk_bf16_f32 v230, v240, v241
    v_cvt_pk_bf16_f32 v238, v242, v243
    v_pk_mul_f32 v[244:245], v[142:143], v[46:47]
    v_pk_mul_f32 v[246:247], v[158:159], v[46:47]
    v_pk_fma_f32 v[244:245], v[158:159], v[62:63], v[244:245]
    v_pk_fma_f32 v[246:247], v[142:143], v[62:63], v[246:247] neg_lo:[0,1,0] neg_hi:[0,1,0]
    v_cvt_pk_bf16_f32 v231, v244, v245
    v_cvt_pk_bf16_f32 v239, v246, v247
    s_cmp_lg_u32 s39, 0
    s_cbranch_scc1 L_spA
    v_mfma_f32_32x32x16_bf16 v[128:143], a[0:3], v[224:227], 0
    v_mfma_f32_32x32x16_bf16 v[144:159], a[0:3], v[232:235], 0
    v_mfma_f32_32x32x16_bf16 v[128:143], a[8:11], v[232:235], v[128:143]
    v_mfma_f32_32x32x16_bf16 v[144:159], a[16:19], v[224:227], v[144:159]
    v_mfma_f32_32x32x16_bf16 v[128:143], a[4:7], v[228:231], v[128:143]
    v_mfma_f32_32x32x16_bf16 v[144:159], a[4:7], v[236:239], v[144:159]
    v_mfma_f32_32x32x16_bf16 v[128:143], a[12:15], v[236:239], v[128:143]
    v_mfma_f32_32x32x16_bf16 v[144:159], a[20:23], v[228:231], v[144:159]
    s_nop 10
    s_nop 0
    v_pk_mul_f32 v[240:241], v[128:129], v[96:97]
    v_pk_mul_f32 v[242:243], v[144:145], v[96:97]
    v_pk_fma_f32 v[240:241], v[144:145], v[112:113], v[240:241] neg_lo:[0,1,0] neg_hi:[0,1,0]
    v_pk_fma_f32 v[242:243], v[128:129], v[112:113], v[242:243]
    v_cvt_pk_bf16_f32 v224, v240, v241
    v_cvt_pk_bf16_f32 v232, v242, v243
    v_pk_mul_f32 v[244:245], v[130:131], v[98:99]
    v_pk_mul_f32 v[246:247], v[146:147], v[98:99]
    v_pk_fma_f32 v[244:245], v[146:147], v[114:115], v[244:245] neg_lo:[0,1,0] neg_hi:[0,1,0]
    v_pk_fma_f32 v[246:247], v[130:131], v[114:115], v[246:247]
    v_cvt_pk_bf16_f32 v225, v244, v245
    v_cvt_pk_bf16_f32 v233, v246, v247
    v_pk_mul_f32 v[240:241], v[132:133], v[100:101]
    v_pk_mul_f32 v[242:243], v[148:149], v[100:101]
    v_pk_fma_f32 v[240:241], v[148:149], v[116:117], v[240:241] neg_lo:[0,1,0] neg_hi:[0,1,0]
    v_pk_fma_f32 v[242:243], v[132:133], v[116:117], v[242:243]
    v_cvt_pk_bf16_f32 v226, v240, v241
    v_cvt_pk_bf16_f32 v234, v242, v243
    v_pk_mul_f32 v[244:245], v[134:135], v[102:103]
    v_pk_mul_f32 v[246:247], v[150:151], v[102:103]
    v_pk_fma_f32 v[244:245], v[150:151], v[118:119], v[244:245] neg_lo:[0,1,0] neg_hi:[0,1,0]
    v_pk_fma_f32 v[246:247], v[134:135], v[118:119], v[246:247]
    v_cvt_pk_bf16_f32 v227, v244, v245
    v_cvt_pk_bf16_f32 v235, v246, v247
    v_pk_mul_f32 v[240:241], v[136:137], v[104:105]
    v_pk_mul_f32 v[242:243], v[152:153], v[104:105]
    v_pk_fma_f32 v[240:241], v[152:153], v[120:121], v[240:241] neg_lo:[0,1,0] neg_hi:[0,1,0]
    v_pk_fma_f32 v[242:243], v[136:137], v[120:121], v[242:243]
    v_cvt_pk_bf16_f32 v228, v240, v241
    v_cvt_pk_bf16_f32 v236, v242, v243
    v_pk_mul_f32 v[244:245], v[138:139], v[106:107]
    v_pk_mul_f32 v[246:247], v[154:155], v[106:107]
    v_pk_fma_f32 v[244:245], v[154:155], v[122:123], v[244:245] neg_lo:[0,1,0] neg_hi:[0,1,0]
    v_pk_fma_f32 v[246:247], v[138:139], v[122:123], v[246:247]
    v_cvt_pk_bf16_f32 v229, v244, v245
    v_cvt_pk_bf16_f32 v237, v246, v247
    v_pk_mul_f32 v[240:241], v[140:141], v[108:109]
    v_pk_mul_f32 v[242:243], v[156:157], v[108:109]
    v_pk_fma_f32 v[240:241], v[156:157], v[124:125], v[240:241] neg_lo:[0,1,0] neg_hi:[0,1,0]
    v_pk_fma_f32 v[242:243], v[140:141], v[124:125], v[242:243]
    v_cvt_pk_bf16_f32 v230, v240, v241
    v_cvt_pk_bf16_f32 v238, v242, v243
    v_pk_mul_f32 v[244:245], v[142:143], v[110:111]
    v_pk_mul_f32 v[246:247], v[158:159], v[110:111]
    v_pk_fma_f32 v[244:245], v[158:159], v[126:127], v[244:245] neg_lo:[0,1,0] neg_hi:[0,1,0]
    v_pk_fma_f32 v[246:247], v[142:143], v[126:127], v[246:247]
    v_cvt_pk_bf16_f32 v231, v244, v245
    v_cvt_pk_bf16_f32 v239, v246, v247
L_spA_r:
    s_cmp_eq_u32 s40, 1
    s_cbranch_scc1 L_li1
    v_mfma_f32_32x32x16_bf16 v[128:143], v[224:227], a[0:3], 0
    v_mfma_f32_32x32x16_bf16 v[144:159], v[232:235], a[0:3], 0
    v_mfma_f32_32x32x16_bf16 v[128:143], v[232:235], a[16:19], v[128:143]
    v_mfma_f32_32x32x16_bf16 v[144:159], v[224:227], a[8:11], v[144:159]
    v_mfma_f32_32x32x16_bf16 v[128:143], v[228:231], a[4:7], v[128:143]
    v_mfma_f32_32x32x16_bf16 v[144:159], v[236:239], a[4:7], v[144:159]
    v_mfma_f32_32x32x16_bf16 v[128:143], v[236:239], a[20:23], v[128:143]
    v_mfma_f32_32x32x16_bf16 v[144:159], v[228:231], a[12:15], v[144:159]
L_li1_r:
    s_nop 10
    s_nop 0
    v_pk_mul_f32 v[240:241], v[128:129], v[64:65]
    v_pk_mul_f32 v[242:243], v[144:145], v[64:65]
    v_pk_fma_f32 v[240:241], v[144:145], v[80:81], v[240:241] neg_lo:[0,1,0] neg_hi:[0,1,0]
    v_pk_fma_f32 v[242:243], v[128:129], v[80:81], v[242:243]
    v_cvt_pk_bf16_f32 v224, v240, v241
    v_cvt_pk_bf16_f32 v232, v242, v243
    v_pk_mul_f32 v[244:245], v[130:131], v[66:67]
    v_pk_mul_f32 v[246:247], v[146:147], v[66:67]
    v_pk_fma_f32 v[244:245], v[146:147], v[82:83], v[244:245] neg_lo:[0,1,0] neg_hi:[0,1,0]
    v_pk_fma_f32 v[246:247], v[130:131], v[82:83], v[246:247]
    v_cvt_pk_bf16_f32 v225, v244, v245
    v_cvt_pk_bf16_f32 v233, v246, v247
    v_pk_mul_f32 v[240:241], v[132:133], v[68:69]
    v_pk_mul_f32 v[242:243], v[148:149], v[68:69]
    v_pk_fma_f32 v[240:241], v[148:149], v[84:85], v[240:241] neg_lo:[0,1,0] neg_hi:[0,1,0]
    v_pk_fma_f32 v[242:243], v[132:133], v[84:85], v[242:243]
    v_cvt_pk_bf16_f32 v226, v240, v241
    v_cvt_pk_bf16_f32 v234, v242, v243
    v_pk_mul_f32 v[244:245], v[134:135], v[70:71]
    v_pk_mul_f32 v[246:247], v[150:151], v[70:71]
    v_pk_fma_f32 v[244:245], v[150:151], v[86:87], v[244:245] neg_lo:[0,1,0] neg_hi:[0,1,0]
    v_pk_fma_f32 v[246:247], v[134:135], v[86:87], v[246:247]
    v_cvt_pk_bf16_f32 v227, v244, v245
    v_cvt_pk_bf16_f32 v235, v246, v247
    v_pk_mul_f32 v[240:241], v[136:137], v[72:73]
    v_pk_mul_f32 v[242:243], v[152:153], v[72:73]
    v_pk_fma_f32 v[240:241], v[152:153], v[88:89], v[240:241] neg_lo:[0,1,0] neg_hi:[0,1,0]
    v_pk_fma_f32 v[242:243], v[136:137], v[88:89], v[242:243]
    v_cvt_pk_bf16_f32 v228, v240, v241
    v_cvt_pk_bf16_f32 v236, v242, v243
    v_pk_mul_f32 v[244:245], v[138:139], v[74:75]
    v_pk_mul_f32 v[246:247], v[154:155], v[74:75]
    v_pk_fma_f32 v[244:245], v[154:155], v[90:91], v[244:245] neg_lo:[0,1,0] neg_hi:[0,1,0]
    v_pk_fma_f32 v[246:247], v[138:139], v[90:91], v[246:247]
    v_cvt_pk_bf16_f32 v229, v244, v245
    v_cvt_pk_bf16_f32 v237, v246, v247
    v_pk_mul_f32 v[240:241], v[140:141], v[76:77]
    v_pk_mul_f32 v[242:243], v[156:157], v[76:77]
    v_pk_fma_f32 v[240:241], v[156:157], v[92:93], v[240:241] neg_lo:[0,1,0] neg_hi:[0,1,0]
    v_pk_fma_f32 v[242:243], v[140:141], v[92:93], v[242:243]
    v_cvt_pk_bf16_f32 v230, v240, v241
    v_cvt_pk_bf16_f32 v238, v242, v243
    v_pk_mul_f32 v[244:245], v[142:143], v[78:79]
    v_pk_mul_f32 v[246:247], v[158:159], v[78:79]
    v_pk_fma_f32 v[244:245], v[158:159], v[94:95], v[244:245] neg_lo:[0,1,0] neg_hi:[0,1,0]
    v_pk_fma_f32 v[246:247], v[142:143], v[94:95], v[246:247]
    v_cvt_pk_bf16_f32 v231, v244, v245
    v_cvt_pk_bf16_f32 v239, v246, v247
    v_mfma_f32_32x32x16_bf16 v[160:175], a[48:51], v[224:227], v[160:175]
    v_accvgpr_read_b32 v128, a96
    v_accvgpr_read_b32 v129, a97
    v_accvgpr_read_b32 v130, a98
    v_accvgpr_read_b32 v131, a99
    v_accvgpr_read_b32 v132, a100
    v_accvgpr_read_b32 v133, a101
    v_mfma_f32_32x32x16_bf16 v[160:175], a[64:67], v[232:235], v[160:175]
    v_accvgpr_read_b32 v134, a102
    v_accvgpr_read_b32 v135, a103
    v_accvgpr_read_b32 v136, a104
    v_accvgpr_read_b32 v137, a105
    v_accvgpr_read_b32 v138, a106
    v_accvgpr_read_b32 v139, a107
    v_mfma_f32_32x32x16_bf16 v[160:175], a[52:55], v[228:231], v[160:175]
    v_accvgpr_read_b32 v140, a108
    v_accvgpr_read_b32 v141, a109
    v_accvgpr_read_b32 v142, a110
    v_accvgpr_read_b32 v143, a111
    v_accvgpr_read_b32 v144, a112
    v_accvgpr_read_b32 v145, a113
    v_mfma_f32_32x32x16_bf16 v[160:175], a[68:71], v[236:239], v[160:175]
    v_accvgpr_read_b32 v146, a114
    v_accvgpr_read_b32 v147, a115
    v_accvgpr_read_b32 v148, a116
    v_accvgpr_read_b32 v149, a117
    v_accvgpr_read_b32 v150, a118
    v_accvgpr_read_b32 v151, a119
    v_mfma_f32_32x32x16_bf16 v[176:191], a[48:51], v[232:235], v[176:191]
    v_accvgpr_read_b32 v152, a120
    v_accvgpr_read_b32 v153, a121
    v_accvgpr_read_b32 v154, a122
    v_accvgpr_read_b32 v155, a123
    v_accvgpr_read_b32 v156, a124
    v_accvgpr_read_b32 v157, a125
    v_mfma_f32_32x32x16_bf16 v[176:191], a[56:59], v[224:227], v[176:191]
    v_accvgpr_read_b32 v158, a126
    v_accvgpr_read_b32 v159, a127
    s_lshl_b32 s41, s36, 13
    v_add_u32 v30, s41, v5
    v_add_u32_e64 v29, s61, v5
    v_mfma_f32_32x32x16_bf16 v[176:191], a[52:55], v[236:239], v[176:191]
    ds_write_b128 v30, v[160:163] offset:16384
    ds_write_b128 v30, v[164:167] offset:17408
    ds_write_b128 v30, v[168:171] offset:18432
    ds_write_b128 v30, v[172:175] offset:19456
    v_mfma_f32_32x32x16_bf16 v[176:191], a[60:63], v[228:231], v[176:191]
    s_nop 11
    s_nop 0
    ds_write_b128 v30, v[176:179] offset:20480
    ds_write_b128 v30, v[180:183] offset:21504
    ds_write_b128 v30, v[184:187] offset:22528
    ds_write_b128 v30, v[188:191] offset:23552
    s_cmp_lg_u32 s40, 3
    s_cbranch_scc1 L_ar
    v_lshrrev_b32 v28, 2, v0
    v_and_b32 v27, 3, v28
    v_bfe_u32 v26, v28, 3, 2
    v_lshl_or_b32 v27, v26, 2, v27
    v_bfe_u32 v26, v28, 2, 1
    v_lshl_or_b32 v27, v26, 4, v27
    v_lshrrev_b32 v26, 5, v28
    v_lshl_add_u32 v27, v26, 7, v27
    v_lshlrev_b32 v27, 14, v27
    v_and_b32 v26, 3, v0
    v_lshl_add_u32 v27, v26, 4, v27
    v_lshlrev_b32 v29, 2, v0
    s_lshl_b32 s41, s2, 6
    s_add_u32 s41, s41, 20971520
    s_waitcnt lgkmcnt(0)
    s_barrier
    s_nop 0
    ds_read2st64_b32 v[128:129], v29 offset0:64 offset1:128
    ds_read2st64_b32 v[130:131], v29 offset0:96 offset1:160
    ds_read2st64_b32 v[132:133], v29 offset0:80 offset1:144
    ds_read2st64_b32 v[134:135], v29 offset0:112 offset1:176
    ds_read2st64_b32 v[136:137], v29 offset0:68 offset1:132
    ds_read2st64_b32 v[138:139], v29 offset0:100 offset1:164
    ds_read2st64_b32 v[140:141], v29 offset0:84 offset1:148
    ds_read2st64_b32 v[142:143], v29 offset0:116 offset1:180
    ds_read2st64_b32 v[144:145], v29 offset0:72 offset1:136
    ds_read2st64_b32 v[146:147], v29 offset0:104 offset1:168
    ds_read2st64_b32 v[148:149], v29 offset0:88 offset1:152
    ds_read2st64_b32 v[150:151], v29 offset0:120 offset1:184
    ds_read2st64_b32 v[152:153], v29 offset0:76 offset1:140
    ds_read2st64_b32 v[154:155], v29 offset0:108 offset1:172
    ds_read2st64_b32 v[156:157], v29 offset0:92 offset1:156
    ds_read2st64_b32 v[158:159], v29 offset0:124 offset1:188
    s_cmp_eq_u32 s2, 0
    s_cselect_b64 s[44:45], -1, 0
    s_waitcnt lgkmcnt(12)
    s_nop 0
    v_pk_add_f32 v[240:241], v[128:129], v[130:131]
    v_pk_add_f32 v[242:243], v[128:129], v[130:131] neg_lo:[0,1] neg_hi:[0,1]
    v_pk_add_f32 v[244:245], v[132:133], v[134:135]
    v_pk_add_f32 v[246:247], v[132:133], v[134:135] neg_lo:[0,1] neg_hi:[0,1]
    v_pk_add_f32 v[248:249], v[240:241], v[246:247] neg_lo:[0,1] neg_hi:[0,1]
    v_pk_add_f32 v[250:251], v[244:245], v[242:243]
    v_pk_add_f32 v[252:253], v[240:241], v[246:247]
    v_pk_add_f32 v[254:255], v[242:243], v[244:245] neg_lo:[0,1] neg_hi:[0,1]
    v_cvt_pk_bf16_f32 v224, v248, v250
    v_cvt_pk_bf16_f32 v225, v253, v255
    v_cvt_pk_bf16_f32 v226, v249, v251
    v_cvt_pk_bf16_f32 v227, v252, v254
    s_mov_b64 exec, s[44:45]
    v_cvt_pk_bf16_f32 v224, v240, v242
    v_cvt_pk_bf16_f32 v225, v244, v246
    v_cvt_pk_bf16_f32 v227, v253, v255
    s_mov_b64 exec, -1
    v_min_u32 v227, -2, v227
    s_add_u32 s47, s41, 0
    buffer_store_dwordx4 v[224:227], v27, s[12:15], s47 offen sc1
    s_waitcnt lgkmcnt(8)
    s_nop 0
    v_pk_add_f32 v[240:241], v[136:137], v[138:139]
    v_pk_add_f32 v[242:243], v[136:137], v[138:139] neg_lo:[0,1] neg_hi:[0,1]
    v_pk_add_f32 v[244:245], v[140:141], v[142:143]
    v_pk_add_f32 v[246:247], v[140:141], v[142:143] neg_lo:[0,1] neg_hi:[0,1]
    v_pk_add_f32 v[248:249], v[240:241], v[246:247] neg_lo:[0,1] neg_hi:[0,1]
    v_pk_add_f32 v[250:251], v[244:245], v[242:243]
    v_pk_add_f32 v[252:253], v[240:241], v[246:247]
    v_pk_add_f32 v[254:255], v[242:243], v[244:245] neg_lo:[0,1] neg_hi:[0,1]
    v_cvt_pk_bf16_f32 v228, v248, v250
    v_cvt_pk_bf16_f32 v229, v253, v255
    v_cvt_pk_bf16_f32 v230, v249, v251
    v_cvt_pk_bf16_f32 v231, v252, v254
    s_mov_b64 exec, s[44:45]
    v_cvt_pk_bf16_f32 v228, v240, v242
    v_cvt_pk_bf16_f32 v229, v244, v246
    v_cvt_pk_bf16_f32 v231, v253, v255
    s_mov_b64 exec, -1
    v_min_u32_e64 v231, -2, v231
    s_add_u32 s47, s41, 524288
    buffer_store_dwordx4 v[228:231], v27, s[12:15], s47 offen sc1
    s_waitcnt lgkmcnt(4)
    s_nop 0
    v_pk_add_f32 v[240:241], v[144:145], v[146:147]
    v_pk_add_f32 v[242:243], v[144:145], v[146:147] neg_lo:[0,1] neg_hi:[0,1]
    v_pk_add_f32 v[244:245], v[148:149], v[150:151]
    v_pk_add_f32 v[246:247], v[148:149], v[150:151] neg_lo:[0,1] neg_hi:[0,1]
    v_pk_add_f32 v[248:249], v[240:241], v[246:247] neg_lo:[0,1] neg_hi:[0,1]
    v_pk_add_f32 v[250:251], v[244:245], v[242:243]
    v_pk_add_f32 v[252:253], v[240:241], v[246:247]
    v_pk_add_f32 v[254:255], v[242:243], v[244:245] neg_lo:[0,1] neg_hi:[0,1]
    v_cvt_pk_bf16_f32 v232, v248, v250
    v_cvt_pk_bf16_f32 v233, v253, v255
    v_cvt_pk_bf16_f32 v234, v249, v251
    v_cvt_pk_bf16_f32 v235, v252, v254
    s_mov_b64 exec, s[44:45]
    v_cvt_pk_bf16_f32 v232, v240, v242
    v_cvt_pk_bf16_f32 v233, v244, v246
    v_cvt_pk_bf16_f32 v235, v253, v255
    s_mov_b64 exec, -1
    v_min_u32_e64 v235, -2, v235
    s_add_u32 s47, s41, 1048576
    buffer_store_dwordx4 v[232:235], v27, s[12:15], s47 offen sc1
    s_waitcnt lgkmcnt(0)
    s_nop 0
    v_pk_add_f32 v[240:241], v[152:153], v[154:155]
    v_pk_add_f32 v[242:243], v[152:153], v[154:155] neg_lo:[0,1] neg_hi:[0,1]
    v_pk_add_f32 v[244:245], v[156:157], v[158:159]
    v_pk_add_f32 v[246:247], v[156:157], v[158:159] neg_lo:[0,1] neg_hi:[0,1]
    v_pk_add_f32 v[248:249], v[240:241], v[246:247] neg_lo:[0,1] neg_hi:[0,1]
    v_pk_add_f32 v[250:251], v[244:245], v[242:243]
    v_pk_add_f32 v[252:253], v[240:241], v[246:247]
    v_pk_add_f32 v[254:255], v[242:243], v[244:245] neg_lo:[0,1] neg_hi:[0,1]
    v_cvt_pk_bf16_f32 v236, v248, v250
    v_cvt_pk_bf16_f32 v237, v253, v255
    v_cvt_pk_bf16_f32 v238, v249, v251
    v_cvt_pk_bf16_f32 v239, v252, v254
    s_mov_b64 exec, s[44:45]
    v_cvt_pk_bf16_f32 v236, v240, v242
    v_cvt_pk_bf16_f32 v237, v244, v246
    v_cvt_pk_bf16_f32 v239, v253, v255
    s_mov_b64 exec, -1
    v_min_u32_e64 v239, -2, v239
    s_add_u32 s47, s41, 1572864
    buffer_store_dwordx4 v[236:239], v27, s[12:15], s47 offen sc1
    s_or_b32 s42, s2, s36
    s_cmp_lg_u32 s42, 0
    s_cbranch_scc1 L_ep_23
    v_mov_b32 v30, s95
    v_mov_b32 v31, 0
    s_mov_b64 exec, 1
    buffer_store_dword v30, v31, s[12:15], 0 offen sc1
    s_mov_b64 exec, -1
L_ep_23:
    v_mul_f32 v28, 0x3d000000, v4
    v_mul_f32 v27, v28, v8
    v_mul_f32 v27, 0.5, v27
    s_mov_b32 s62, 0x3a800000
    v_add_f32 v23, v27, v28
    v_cos_f32 v128, v27
    v_sin_f32 v144, v27
    v_cos_f32 v129, v23
    v_sin_f32 v145, v23
    v_add_f32 v23, v28, v28
    v_cos_f32 v20, v23
    v_sin_f32_e64 v21, v23
    v_pk_mul_f32 v[128:129], v[128:129], s[62:63] op_sel_hi:[1,0]
    v_pk_mul_f32 v[144:145], v[144:145], s[62:63] op_sel_hi:[1,0]
    v_pk_mul_f32 v[130:131], v[128:129], v[20:21] op_sel_hi:[1,0]
    v_pk_mul_f32 v[146:147], v[144:145], v[20:21] op_sel_hi:[1,0]
    v_pk_fma_f32 v[130:131], v[144:145], v[20:21], v[130:131] op_sel:[0,1,0] op_sel_hi:[1,1,1] neg_lo:[0,1,0] neg_hi:[0,1,0]
    v_pk_fma_f32 v[146:147], v[128:129], v[20:21], v[146:147] op_sel:[0,1,0] op_sel_hi:[1,1,1]
    v_pk_mul_f32 v[132:133], v[130:131], v[20:21] op_sel_hi:[1,0]
    v_pk_mul_f32 v[148:149], v[146:147], v[20:21] op_sel_hi:[1,0]
    v_pk_fma_f32 v[132:133], v[146:147], v[20:21], v[132:133] op_sel:[0,1,0] op_sel_hi:[1,1,1] neg_lo:[0,1,0] neg_hi:[0,1,0]
    v_pk_fma_f32 v[148:149], v[130:131], v[20:21], v[148:149] op_sel:[0,1,0] op_sel_hi:[1,1,1]
    v_pk_mul_f32 v[134:135], v[132:133], v[20:21] op_sel_hi:[1,0]
    v_pk_mul_f32 v[150:151], v[148:149], v[20:21] op_sel_hi:[1,0]
    v_pk_fma_f32 v[134:135], v[148:149], v[20:21], v[134:135] op_sel:[0,1,0] op_sel_hi:[1,1,1] neg_lo:[0,1,0] neg_hi:[0,1,0]
    v_pk_fma_f32 v[150:151], v[132:133], v[20:21], v[150:151] op_sel:[0,1,0] op_sel_hi:[1,1,1]
    v_and_b32_e64 v26, 1, v2
    v_mul_u32_u24 v26, 0x8000, v26
    v_lshl_or_b32 v26, v26, 16, v26
    v_cvt_pk_bf16_f32 v240, v128, -v144
    v_cvt_pk_bf16_f32 v241, v144, v128
    v_xor_b32 v242, v26, v240
    v_xor_b32 v243, v26, v241
    v_accvgpr_write_b32 a192, v240
    v_accvgpr_write_b32 a208, v241
    v_accvgpr_write_b32 a193, v242
    v_accvgpr_write_b32 a209, v243
    v_cvt_pk_bf16_f32 v244, v129, -v145
    v_cvt_pk_bf16_f32 v245, v145, v129
    v_xor_b32 v246, v26, v244
    v_xor_b32 v247, v26, v245
    v_accvgpr_write_b32 a194, v244
    v_accvgpr_write_b32 a210, v245
    v_accvgpr_write_b32 a195, v246
    v_accvgpr_write_b32 a211, v247
    v_cvt_pk_bf16_f32 v240, v130, -v146
    v_cvt_pk_bf16_f32 v241, v146, v130
    v_xor_b32 v242, v26, v240
    v_xor_b32 v243, v26, v241
    v_accvgpr_write_b32 a196, v240
    v_accvgpr_write_b32 a212, v241
    v_accvgpr_write_b32 a197, v242
    v_accvgpr_write_b32 a213, v243
    v_cvt_pk_bf16_f32 v244, v131, -v147
    v_cvt_pk_bf16_f32 v245, v147, v131
    v_xor_b32 v246, v26, v244
    v_xor_b32 v247, v26, v245
    v_accvgpr_write_b32 a198, v244
    v_accvgpr_write_b32 a214, v245
    v_accvgpr_write_b32 a199, v246
    v_accvgpr_write_b32 a215, v247
    v_cvt_pk_bf16_f32 v240, v132, -v148
    v_cvt_pk_bf16_f32 v241, v148, v132
    v_xor_b32 v242, v26, v240
    v_xor_b32 v243, v26, v241
    v_accvgpr_write_b32 a200, v240
    v_accvgpr_write_b32 a216, v241
    v_accvgpr_write_b32 a201, v242
    v_accvgpr_write_b32 a217, v243
    v_cvt_pk_bf16_f32 v244, v133, -v149
    v_cvt_pk_bf16_f32 v245, v149, v133
    v_xor_b32 v246, v26, v244
    v_xor_b32 v247, v26, v245
    v_accvgpr_write_b32 a202, v244
    v_accvgpr_write_b32 a218, v245
    v_accvgpr_write_b32 a203, v246
    v_accvgpr_write_b32 a219, v247
    v_cvt_pk_bf16_f32 v240, v134, -v150
    v_cvt_pk_bf16_f32 v241, v150, v134
    v_xor_b32 v242, v26, v240
    v_xor_b32 v243, v26, v241
    v_accvgpr_write_b32 a204, v240
    v_accvgpr_write_b32 a220, v241
    v_accvgpr_write_b32 a205, v242
    v_accvgpr_write_b32 a221, v243
    v_cvt_pk_bf16_f32 v244, v135, -v151
    v_cvt_pk_bf16_f32 v245, v151, v135
    v_xor_b32 v246, v26, v244
    v_xor_b32 v247, v26, v245
    v_accvgpr_write_b32 a206, v244
    v_accvgpr_write_b32 a222, v245
    v_accvgpr_write_b32 a207, v246
    v_accvgpr_write_b32 a223, v247
    v_mul_f32 v28, 0x3a800000, v4
    v_mul_f32 v27, v28, v8
    v_add_f32 v23, v27, v28
    v_cos_f32 v32, v27
    v_sin_f32 v48, v27
    v_cos_f32 v33, v23
    v_sin_f32 v49, v23
    v_add_f32 v23, v28, v28
    v_cos_f32 v20, v23
    v_sin_f32 v21, v23
    s_nop 0
    v_pk_mul_f32 v[34:35], v[32:33], v[20:21] op_sel_hi:[1,0]
    v_pk_mul_f32 v[50:51], v[48:49], v[20:21] op_sel_hi:[1,0]
    v_pk_fma_f32 v[34:35], v[48:49], v[20:21], v[34:35] op_sel:[0,1,0] op_sel_hi:[1,1,1] neg_lo:[0,1,0] neg_hi:[0,1,0]
    v_pk_fma_f32 v[50:51], v[32:33], v[20:21], v[50:51] op_sel:[0,1,0] op_sel_hi:[1,1,1]
    v_pk_mul_f32 v[36:37], v[34:35], v[20:21] op_sel_hi:[1,0]
    v_pk_mul_f32 v[52:53], v[50:51], v[20:21] op_sel_hi:[1,0]
    v_pk_fma_f32 v[36:37], v[50:51], v[20:21], v[36:37] op_sel:[0,1,0] op_sel_hi:[1,1,1] neg_lo:[0,1,0] neg_hi:[0,1,0]
    v_pk_fma_f32 v[52:53], v[34:35], v[20:21], v[52:53] op_sel:[0,1,0] op_sel_hi:[1,1,1]
    v_pk_mul_f32 v[38:39], v[36:37], v[20:21] op_sel_hi:[1,0]
    v_pk_mul_f32 v[54:55], v[52:53], v[20:21] op_sel_hi:[1,0]
    v_pk_fma_f32 v[38:39], v[52:53], v[20:21], v[38:39] op_sel:[0,1,0] op_sel_hi:[1,1,1] neg_lo:[0,1,0] neg_hi:[0,1,0]
    v_pk_fma_f32 v[54:55], v[36:37], v[20:21], v[54:55] op_sel:[0,1,0] op_sel_hi:[1,1,1]
    v_pk_mul_f32 v[40:41], v[38:39], v[20:21] op_sel_hi:[1,0]
    v_pk_mul_f32 v[56:57], v[54:55], v[20:21] op_sel_hi:[1,0]
    v_pk_fma_f32 v[40:41], v[54:55], v[20:21], v[40:41] op_sel:[0,1,0] op_sel_hi:[1,1,1] neg_lo:[0,1,0] neg_hi:[0,1,0]
    v_pk_fma_f32 v[56:57], v[38:39], v[20:21], v[56:57] op_sel:[0,1,0] op_sel_hi:[1,1,1]
    v_pk_mul_f32 v[42:43], v[40:41], v[20:21] op_sel_hi:[1,0]
    v_pk_mul_f32 v[58:59], v[56:57], v[20:21] op_sel_hi:[1,0]
    v_pk_fma_f32 v[42:43], v[56:57], v[20:21], v[42:43] op_sel:[0,1,0] op_sel_hi:[1,1,1] neg_lo:[0,1,0] neg_hi:[0,1,0]
    v_pk_fma_f32 v[58:59], v[40:41], v[20:21], v[58:59] op_sel:[0,1,0] op_sel_hi:[1,1,1]
    v_pk_mul_f32 v[44:45], v[42:43], v[20:21] op_sel_hi:[1,0]
    v_pk_mul_f32 v[60:61], v[58:59], v[20:21] op_sel_hi:[1,0]
    v_pk_fma_f32 v[44:45], v[58:59], v[20:21], v[44:45] op_sel:[0,1,0] op_sel_hi:[1,1,1] neg_lo:[0,1,0] neg_hi:[0,1,0]
    v_pk_fma_f32 v[60:61], v[42:43], v[20:21], v[60:61] op_sel:[0,1,0] op_sel_hi:[1,1,1]
    v_pk_mul_f32 v[46:47], v[44:45], v[20:21] op_sel_hi:[1,0]
    v_pk_mul_f32 v[62:63], v[60:61], v[20:21] op_sel_hi:[1,0]
    v_pk_fma_f32 v[46:47], v[60:61], v[20:21], v[46:47] op_sel:[0,1,0] op_sel_hi:[1,1,1] neg_lo:[0,1,0] neg_hi:[0,1,0]
    v_pk_fma_f32 v[62:63], v[44:45], v[20:21], v[62:63] op_sel:[0,1,0] op_sel_hi:[1,1,1]
    v_mfma_f32_32x32x16_bf16 v[160:175], a[72:75], a[80:83], 0
    v_mfma_f32_32x32x16_bf16 v[176:191], a[72:75], a[88:91], 0
    v_mfma_f32_32x32x16_bf16 v[160:175], a[76:79], a[84:87], v[160:175]
    v_mfma_f32_32x32x16_bf16 v[176:191], a[76:79], a[92:95], v[176:191]
    v_lshrrev_b32 v28, 2, v0
    v_and_b32 v29, 3, v0
    v_lshlrev_b32 v29, 12, v29
    v_add_u32 v29, 0, v29
    v_and_b32 v25, 31, v28
    v_and_b32 v24, 3, v25
    v_bfe_u32 v23, v25, 4, 1
    v_lshl_or_b32 v24, v23, 2, v24
    v_bfe_u32 v23, v25, 2, 2
    v_lshl_or_b32 v24, v23, 3, v24
    v_lshl_add_u32 v12, v24, 4, v29
    v_bfe_u32 v24, v28, 5, 1
    v_lshl_add_u32 v12, v24, 3, v12
    v_bfe_u32 v24, v28, 6, 2
    v_lshl_add_u32 v12, v24, 10, v12
    v_bfe_u32 v24, v28, 8, 1
    v_lshl_add_u32 v12, v24, 9, v12
    v_add_u32 v26, 0, v28
    v_sub_u32 v27, 0x200, v26
    v_cmp_eq_u32 vcc, 0, v26
    v_mov_b32 v24, 0x100
    s_nop 0
    v_cndmask_b32 v27, v27, v24, vcc
    v_and_b32 v25, 31, v27
    v_and_b32 v24, 3, v25
    v_bfe_u32 v23, v25, 4, 1
    v_lshl_or_b32 v24, v23, 2, v24
    v_bfe_u32 v23, v25, 2, 2
    v_lshl_or_b32 v24, v23, 3, v24
    v_lshl_add_u32 v13, v24, 4, v29
    v_bfe_u32 v24, v27, 5, 1
    v_lshl_add_u32 v13, v24, 3, v13
    v_bfe_u32 v24, v27, 6, 2
    v_lshl_add_u32 v13, v24, 10, v13
    v_bfe_u32 v24, v27, 8, 1
    v_lshl_add_u32 v13, v24, 9, v13
    v_add_u32 v26, 64, v28
    v_sub_u32 v27, 0x200, v26
    v_and_b32 v25, 31, v27
    v_and_b32_e64 v24, 3, v25
    v_bfe_u32 v23, v25, 4, 1
    v_lshl_or_b32 v24, v23, 2, v24
    v_bfe_u32 v23, v25, 2, 2
    v_lshl_or_b32 v24, v23, 3, v24
    v_lshl_add_u32 v14, v24, 4, v29
    v_bfe_u32 v24, v27, 5, 1
    v_lshl_add_u32 v14, v24, 3, v14
    v_bfe_u32 v24, v27, 6, 2
    v_lshl_add_u32 v14, v24, 10, v14
    v_bfe_u32 v24, v27, 8, 1
    v_lshl_add_u32 v14, v24, 9, v14
    v_add_u32 v26, 128, v28
    v_sub_u32 v27, 0x200, v26
    v_and_b32 v25, 31, v27
    v_and_b32 v24, 3, v25
    v_bfe_u32 v23, v25, 4, 1
    v_lshl_or_b32 v24, v23, 2, v24
    v_bfe_u32 v23, v25, 2, 2
    v_lshl_or_b32 v24, v23, 3, v24
    v_lshl_add_u32 v15, v24, 4, v29
    v_bfe_u32 v24, v27, 5, 1
    v_lshl_add_u32 v15, v24, 3, v15
    v_bfe_u32 v24, v27, 6, 2
    v_lshl_add_u32 v15, v24, 10, v15
    v_bfe_u32 v24, v27, 8, 1
    v_lshl_add_u32 v15, v24, 9, v15
    v_add_u32 v26, 192, v28
    v_sub_u32 v27, 0x200, v26
    v_and_b32 v25, 31, v27
    v_and_b32 v24, 3, v25
    v_bfe_u32 v23, v25, 4, 1
    v_lshl_or_b32 v24, v23, 2, v24
    v_bfe_u32 v23, v25, 2, 2
    v_lshl_or_b32 v24, v23, 3, v24
    v_lshl_add_u32 v16, v24, 4, v29
    v_bfe_u32 v24, v27, 5, 1
    v_lshl_add_u32 v16, v24, 3, v16
    v_bfe_u32 v24, v27, 6, 2
    v_lshl_add_u32 v16, v24, 10, v16
    v_bfe_u32 v24, v27, 8, 1
    v_lshl_add_u32 v16, v24, 9, v16
    s_add_u32 s42, s58, 20971520
    s_mov_b32 s90, s42
    s_add_u32 s91, s42, 4096
    s_add_u32 s92, s42, 8192
    s_add_u32 s93, s42, 12288
    s_waitcnt vmcnt(0)
    s_mov_b32 s46, 0
L_pb_24:
    s_nop 0
    buffer_load_dwordx4 v[128:131], v6, s[12:15], s90 offen offset:0 sc1
    buffer_load_dwordx4 v[132:135], v6, s[12:15], s91 offen offset:0 sc1
    buffer_load_dwordx4 v[136:139], v6, s[12:15], s92 offen offset:0 sc1
    buffer_load_dwordx4 v[140:143], v6, s[12:15], s93 offen offset:0 sc1
    s_waitcnt vmcnt(0)
    v_max_u32 v31, v131, v135
    v_max3_u32 v31, v31, v139, v143
    v_cmp_eq_u32 vcc, -1, v31
    s_nop 0
    s_cbranch_vccnz L_pb_24_s
    s_mov_b64 exec, -1
    ds_write_b64 v12, v[128:129] offset:0
    ds_write_b64 v13, v[130:131]
    ds_write_b64 v12, v[132:133] offset:1024
    ds_write_b64 v14, v[134:135]
    ds_write_b64 v12, v[136:137] offset:2048
    ds_write_b64 v15, v[138:139]
    ds_write_b64 v12, v[140:141] offset:3072
    ds_write_b64 v16, v[142:143]
    s_waitcnt lgkmcnt(0)
    s_barrier
    ds_read_b128 v[224:227], v10 offset:0
    ds_read_b128 v[228:231], v10 offset:1024
    ds_read_b128 v[232:235], v10 offset:2048
    ds_read_b128 v[236:239], v10 offset:3072
    s_waitcnt lgkmcnt(3)
    v_mfma_f32_32x32x16_bf16 v[128:143], v[224:227], a[192:195], 0
    v_mfma_f32_32x32x16_bf16 v[144:159], v[224:227], a[208:211], 0
    s_waitcnt lgkmcnt(2)
    v_mfma_f32_32x32x16_bf16 v[128:143], v[228:231], a[196:199], v[128:143]
    v_mfma_f32_32x32x16_bf16 v[144:159], v[228:231], a[212:215], v[144:159]
    s_waitcnt lgkmcnt(1)
    v_mfma_f32_32x32x16_bf16 v[128:143], v[232:235], a[200:203], v[128:143]
    v_mfma_f32_32x32x16_bf16 v[144:159], v[232:235], a[216:219], v[144:159]
    s_waitcnt lgkmcnt(0)
    v_mfma_f32_32x32x16_bf16 v[128:143], v[236:239], a[204:207], v[128:143]
    v_mfma_f32_32x32x16_bf16 v[144:159], v[236:239], a[220:223], v[144:159]
    s_nop 10
    s_nop 0
    v_pk_mul_f32 v[240:241], v[128:129], v[32:33]
    v_pk_mul_f32 v[242:243], v[144:145], v[32:33]
    v_pk_fma_f32 v[240:241], v[144:145], v[48:49], v[240:241] neg_lo:[0,1,0] neg_hi:[0,1,0]
    v_pk_fma_f32 v[242:243], v[128:129], v[48:49], v[242:243]
    v_cvt_pk_bf16_f32 v224, v240, v241
    v_cvt_pk_bf16_f32 v232, v242, v243
    v_pk_mul_f32 v[244:245], v[130:131], v[34:35]
    v_pk_mul_f32 v[246:247], v[146:147], v[34:35]
    v_pk_fma_f32 v[244:245], v[146:147], v[50:51], v[244:245] neg_lo:[0,1,0] neg_hi:[0,1,0]
    v_pk_fma_f32 v[246:247], v[130:131], v[50:51], v[246:247]
    v_cvt_pk_bf16_f32 v225, v244, v245
    v_cvt_pk_bf16_f32 v233, v246, v247
    v_pk_mul_f32 v[240:241], v[132:133], v[36:37]
    v_pk_mul_f32 v[242:243], v[148:149], v[36:37]
    v_pk_fma_f32 v[240:241], v[148:149], v[52:53], v[240:241] neg_lo:[0,1,0] neg_hi:[0,1,0]
    v_pk_fma_f32 v[242:243], v[132:133], v[52:53], v[242:243]
    v_cvt_pk_bf16_f32 v226, v240, v241
    v_cvt_pk_bf16_f32 v234, v242, v243
    v_pk_mul_f32 v[244:245], v[134:135], v[38:39]
    v_pk_mul_f32 v[246:247], v[150:151], v[38:39]
    v_pk_fma_f32 v[244:245], v[150:151], v[54:55], v[244:245] neg_lo:[0,1,0] neg_hi:[0,1,0]
    v_pk_fma_f32 v[246:247], v[134:135], v[54:55], v[246:247]
    v_cvt_pk_bf16_f32 v227, v244, v245
    v_cvt_pk_bf16_f32 v235, v246, v247
    v_pk_mul_f32 v[240:241], v[136:137], v[40:41]
    v_pk_mul_f32 v[242:243], v[152:153], v[40:41]
    v_pk_fma_f32 v[240:241], v[152:153], v[56:57], v[240:241] neg_lo:[0,1,0] neg_hi:[0,1,0]
    v_pk_fma_f32 v[242:243], v[136:137], v[56:57], v[242:243]
    v_cvt_pk_bf16_f32 v228, v240, v241
    v_cvt_pk_bf16_f32 v236, v242, v243
    v_pk_mul_f32 v[244:245], v[138:139], v[42:43]
    v_pk_mul_f32 v[246:247], v[154:155], v[42:43]
    v_pk_fma_f32 v[244:245], v[154:155], v[58:59], v[244:245] neg_lo:[0,1,0] neg_hi:[0,1,0]
    v_pk_fma_f32 v[246:247], v[138:139], v[58:59], v[246:247]
    v_cvt_pk_bf16_f32 v229, v244, v245
    v_cvt_pk_bf16_f32 v237, v246, v247
    v_pk_mul_f32 v[240:241], v[140:141], v[44:45]
    v_pk_mul_f32 v[242:243], v[156:157], v[44:45]
    v_pk_fma_f32 v[240:241], v[156:157], v[60:61], v[240:241] neg_lo:[0,1,0] neg_hi:[0,1,0]
    v_pk_fma_f32 v[242:243], v[140:141], v[60:61], v[242:243]
    v_cvt_pk_bf16_f32 v230, v240, v241
    v_cvt_pk_bf16_f32 v238, v242, v243
    v_pk_mul_f32 v[244:245], v[142:143], v[46:47]
    v_pk_mul_f32 v[246:247], v[158:159], v[46:47]
    v_pk_fma_f32 v[244:245], v[158:159], v[62:63], v[244:245] neg_lo:[0,1,0] neg_hi:[0,1,0]
    v_pk_fma_f32 v[246:247], v[142:143], v[62:63], v[246:247]
    v_cvt_pk_bf16_f32 v231, v244, v245
    v_cvt_pk_bf16_f32 v239, v246, v247
    s_lshl_b32 s41, s36, 12
    s_add_u32 s41, s41, 16384
    v_add_u32 v30, s41, v7
    v_add_u32_e64 v29, s41, v5
    v_mfma_f32_32x32x16_bf16 v[160:175], v[224:227], a[0:3], v[160:175]
    v_mfma_f32_32x32x16_bf16 v[160:175], v[232:235], a[16:19], v[160:175]
    v_mfma_f32_32x32x16_bf16 v[160:175], v[228:231], a[4:7], v[160:175]
    v_mfma_f32_32x32x16_bf16 v[160:175], v[236:239], a[20:23], v[160:175]
    v_mfma_f32_32x32x16_bf16 v[176:191], v[232:235], a[0:3], v[176:191]
    v_mfma_f32_32x32x16_bf16 v[176:191], v[224:227], a[8:11], v[176:191]
    v_mfma_f32_32x32x16_bf16 v[176:191], v[236:239], a[4:7], v[176:191]
    s_nop 8
    s_nop 0
    v_cvt_pk_bf16_f32 v128, v160, v161
    v_cvt_pk_bf16_f32 v129, v162, v163
    v_cvt_pk_bf16_f32 v130, v164, v165
    v_cvt_pk_bf16_f32 v131, v166, v167
    v_cvt_pk_bf16_f32 v132, v168, v169
    v_cvt_pk_bf16_f32 v133, v170, v171
    v_cvt_pk_bf16_f32 v134, v172, v173
    v_cvt_pk_bf16_f32 v135, v174, v175
    ds_write_b128 v30, v[128:131] offset:0
    ds_write_b128 v30, v[132:135] offset:16
    ds_read_b128 v[144:147], v29 offset:0
    ds_read_b128 v[148:151], v29 offset:1024
    v_mfma_f32_32x32x16_bf16 v[176:191], v[228:231], a[12:15], v[176:191]
    s_nop 11
    s_nop 0
    v_cvt_pk_bf16_f32 v136, v176, v177
    v_cvt_pk_bf16_f32 v137, v178, v179
    v_cvt_pk_bf16_f32 v138, v180, v181
    v_cvt_pk_bf16_f32 v139, v182, v183
    v_cvt_pk_bf16_f32 v140, v184, v185
    v_cvt_pk_bf16_f32 v141, v186, v187
    v_cvt_pk_bf16_f32 v142, v188, v189
    v_cvt_pk_bf16_f32 v143, v190, v191
    ds_write_b128 v30, v[136:139] offset:2048
    ds_write_b128 v30, v[140:143] offset:2064
    ds_read_b128 v[152:155], v29 offset:2048
    ds_read_b128 v[156:159], v29 offset:3072
    s_waitcnt lgkmcnt(4)
    buffer_store_dwordx4 v[144:147], v5, s[8:11], s50 offen offset:0 sc1
    buffer_store_dwordx4 v[148:151], v5, s[8:11], s50 offen offset:1024 sc1
    s_waitcnt lgkmcnt(0)
    buffer_store_dwordx4 v[152:155], v5, s[8:11], s51 offen offset:0 sc1
    buffer_store_dwordx4 v[156:159], v5, s[8:11], s51 offen offset:1024 sc1
    s_endpgm
L_ps_13:
    s_nop 0
    v_pk_mul_f32 v[30:31], v[164:165], 0.5 op_sel_hi:[1,0]
    v_pk_fma_f32 v[12:13], v[30:31], v[164:165], v[12:13]
    v_pk_mul_f32 v[30:31], v[166:167], 0.5 op_sel_hi:[1,0]
    v_pk_fma_f32 v[14:15], v[30:31], v[166:167], v[14:15]
    v_pk_mul_f32 v[30:31], v[172:173], 0.5 op_sel_hi:[1,0]
    v_pk_fma_f32 v[16:17], v[30:31], v[172:173], v[16:17]
    v_pk_mul_f32 v[30:31], v[174:175], 0.5 op_sel_hi:[1,0]
    v_pk_fma_f32 v[18:19], v[30:31], v[174:175], v[18:19]
    s_branch L_pe_14
L_ps_16:
    s_nop 0
    v_pk_mul_f32 v[30:31], v[132:133], 0.5 op_sel_hi:[1,0]
    v_pk_fma_f32 v[240:241], v[30:31], v[132:133], v[240:241]
    v_pk_mul_f32 v[30:31], v[134:135], 0.5 op_sel_hi:[1,0]
    v_pk_fma_f32 v[242:243], v[30:31], v[134:135], v[242:243]
    v_pk_mul_f32 v[30:31], v[140:141], 0.5 op_sel_hi:[1,0]
    v_pk_fma_f32 v[244:245], v[30:31], v[140:141], v[244:245]
    v_pk_mul_f32 v[30:31], v[142:143], 0.5 op_sel_hi:[1,0]
    v_pk_fma_f32 v[246:247], v[30:31], v[142:143], v[246:247]
    s_branch L_pe_17
L_spA:
    s_nop 0
    v_mfma_f32_32x32x16_bf16 v[128:143], a[0:3], v[224:227], 0
    v_accvgpr_read_b32 v29, a248
    v_accvgpr_read_b32 v30, a249
    v_mfma_f32_32x32x16_bf16 v[128:143], a[8:11], v[232:235], v[128:143]
    v_mfma_f32_32x32x16_bf16 v[128:143], a[4:7], v[228:231], v[128:143]
    v_mfma_f32_32x32x16_bf16 v[128:143], a[12:15], v[236:239], v[128:143]
    v_mfma_f32_32x32x16_bf16 v[144:159], a[0:3], v[232:235], 0
    v_mfma_f32_32x32x16_bf16 v[144:159], a[16:19], v[224:227], v[144:159]
    v_mfma_f32_32x32x16_bf16 v[144:159], a[4:7], v[236:239], v[144:159]
    s_nop 8
    s_nop 0
    ds_write_b128 v30, v[128:131] offset:0
    ds_write_b128 v30, v[132:135] offset:16
    ds_write_b128 v30, v[136:139] offset:32
    ds_write_b128 v30, v[140:143] offset:48
    s_mov_b64 exec, 1
    ds_write_b32 v30, v128 offset:128
    s_mov_b64 exec, -1
    v_mfma_f32_32x32x16_bf16 v[144:159], a[20:23], v[228:231], v[144:159]
    s_branch L_spJ
L_psp_10:
    s_nop 0
    ds_write_b128 v30, v[128:131] offset:0
    ds_write_b128 v30, v[132:135] offset:16
    ds_write_b128 v30, v[136:139] offset:32
    ds_write_b128 v30, v[140:143] offset:48
    s_mov_b64 exec, 1
    ds_write_b32 v30, v128 offset:128
    s_mov_b64 exec, -1
L_spJ:
    ds_read_b128 v[224:227], v29 offset:0
    ds_read_b128 v[228:231], v29 offset:16
    ds_read_b128 v[232:235], v29 offset:32
    ds_read_b128 v[236:239], v29 offset:48
    s_nop 6
    s_nop 0
    ds_write_b128 v30, v[144:147] offset:4864
    ds_write_b128 v30, v[148:151] offset:4880
    ds_write_b128 v30, v[152:155] offset:4896
    ds_write_b128 v30, v[156:159] offset:4912
    s_mov_b64 exec, 1
    ds_write_b32 v30, v144 offset:4992
    s_mov_b64 exec, -1
    ds_read_b128 v[248:251], v29 offset:4864
    ds_read_b128 v[252:255], v29 offset:4880
    ds_read_b128 v[24:27], v29 offset:4896
    v_pk_mul_f32 v[240:241], v[128:129], v[96:97]
    v_pk_mul_f32 v[242:243], v[128:129], v[112:113]
    v_pk_fma_f32 v[128:129], v[144:145], v[112:113], v[240:241] neg_lo:[0,1,0] neg_hi:[0,1,0]
    v_pk_fma_f32 v[144:145], v[144:145], v[96:97], v[242:243]
    v_pk_mul_f32 v[244:245], v[130:131], v[98:99]
    v_pk_mul_f32 v[246:247], v[130:131], v[114:115]
    v_pk_fma_f32 v[130:131], v[146:147], v[114:115], v[244:245] neg_lo:[0,1,0] neg_hi:[0,1,0]
    v_pk_fma_f32 v[146:147], v[146:147], v[98:99], v[246:247]
    ds_read_b128 v[96:99], v29 offset:4912
    v_pk_mul_f32 v[240:241], v[132:133], v[100:101]
    v_pk_mul_f32 v[242:243], v[132:133], v[116:117]
    v_pk_fma_f32 v[132:133], v[148:149], v[116:117], v[240:241] neg_lo:[0,1,0] neg_hi:[0,1,0]
    v_pk_fma_f32 v[148:149], v[148:149], v[100:101], v[242:243]
    v_pk_mul_f32 v[244:245], v[134:135], v[102:103]
    v_pk_mul_f32 v[246:247], v[134:135], v[118:119]
    v_pk_fma_f32 v[134:135], v[150:151], v[118:119], v[244:245] neg_lo:[0,1,0] neg_hi:[0,1,0]
    v_pk_fma_f32 v[150:151], v[150:151], v[102:103], v[246:247]
    v_pk_mul_f32 v[240:241], v[136:137], v[104:105]
    v_pk_mul_f32 v[242:243], v[136:137], v[120:121]
    v_pk_fma_f32 v[136:137], v[152:153], v[120:121], v[240:241] neg_lo:[0,1,0] neg_hi:[0,1,0]
    v_pk_fma_f32 v[152:153], v[152:153], v[104:105], v[242:243]
    v_pk_mul_f32 v[244:245], v[138:139], v[106:107]
    v_pk_mul_f32 v[246:247], v[138:139], v[122:123]
    v_pk_fma_f32 v[138:139], v[154:155], v[122:123], v[244:245] neg_lo:[0,1,0] neg_hi:[0,1,0]
    v_pk_fma_f32 v[154:155], v[154:155], v[106:107], v[246:247]
    v_pk_mul_f32 v[240:241], v[140:141], v[108:109]
    v_pk_mul_f32 v[242:243], v[140:141], v[124:125]
    v_pk_fma_f32 v[140:141], v[156:157], v[124:125], v[240:241] neg_lo:[0,1,0] neg_hi:[0,1,0]
    v_pk_fma_f32 v[156:157], v[156:157], v[108:109], v[242:243]
    v_pk_mul_f32 v[244:245], v[142:143], v[110:111]
    v_pk_mul_f32 v[246:247], v[142:143], v[126:127]
    v_pk_fma_f32 v[142:143], v[158:159], v[126:127], v[244:245] neg_lo:[0,1,0] neg_hi:[0,1,0]
    v_pk_fma_f32 v[158:159], v[158:159], v[110:111], v[246:247]
    s_waitcnt lgkmcnt(9)
    s_nop 0
    v_pk_fma_f32 v[128:129], v[238:239], v[192:193], v[128:129] op_sel:[1,0,0] op_sel_hi:[0,1,1]
    v_pk_fma_f32 v[144:145], v[238:239], v[208:209], v[144:145] op_sel:[1,0,0] op_sel_hi:[0,1,1]
    v_pk_fma_f32 v[130:131], v[236:237], v[194:195], v[130:131] op_sel:[1,0,0] op_sel_hi:[0,1,1]
    v_pk_fma_f32 v[146:147], v[236:237], v[210:211], v[146:147] op_sel:[1,0,0] op_sel_hi:[0,1,1]
    v_pk_fma_f32 v[132:133], v[234:235], v[196:197], v[132:133] op_sel:[1,0,0] op_sel_hi:[0,1,1]
    v_pk_fma_f32 v[148:149], v[234:235], v[212:213], v[148:149] op_sel:[1,0,0] op_sel_hi:[0,1,1]
    v_pk_fma_f32 v[134:135], v[232:233], v[198:199], v[134:135] op_sel:[1,0,0] op_sel_hi:[0,1,1]
    v_pk_fma_f32 v[150:151], v[232:233], v[214:215], v[150:151] op_sel:[1,0,0] op_sel_hi:[0,1,1]
    v_pk_fma_f32 v[136:137], v[230:231], v[200:201], v[136:137] op_sel:[1,0,0] op_sel_hi:[0,1,1]
    v_pk_fma_f32 v[152:153], v[230:231], v[216:217], v[152:153] op_sel:[1,0,0] op_sel_hi:[0,1,1]
    v_pk_fma_f32 v[138:139], v[228:229], v[202:203], v[138:139] op_sel:[1,0,0] op_sel_hi:[0,1,1]
    v_pk_fma_f32 v[154:155], v[228:229], v[218:219], v[154:155] op_sel:[1,0,0] op_sel_hi:[0,1,1]
    v_pk_fma_f32 v[140:141], v[226:227], v[204:205], v[140:141] op_sel:[1,0,0] op_sel_hi:[0,1,1]
    v_pk_fma_f32 v[156:157], v[226:227], v[220:221], v[156:157] op_sel:[1,0,0] op_sel_hi:[0,1,1]
    v_pk_fma_f32 v[142:143], v[224:225], v[206:207], v[142:143] op_sel:[1,0,0] op_sel_hi:[0,1,1]
    v_pk_fma_f32 v[158:159], v[224:225], v[222:223], v[158:159] op_sel:[1,0,0] op_sel_hi:[0,1,1]
    s_waitcnt lgkmcnt(0)
    s_nop 0
    v_pk_fma_f32 v[128:129], v[98:99], v[208:209], v[128:129] op_sel:[1,0,0] op_sel_hi:[0,1,1]
    v_pk_fma_f32 v[144:145], v[98:99], v[192:193], v[144:145] op_sel:[1,0,0] op_sel_hi:[0,1,1] neg_lo:[0,1,0] neg_hi:[0,1,0]
    v_cvt_pk_bf16_f32 v224, v128, v129
    v_cvt_pk_bf16_f32 v232, v144, v145
    v_pk_fma_f32 v[130:131], v[96:97], v[210:211], v[130:131] op_sel:[1,0,0] op_sel_hi:[0,1,1]
    v_pk_fma_f32 v[146:147], v[96:97], v[194:195], v[146:147] op_sel:[1,0,0] op_sel_hi:[0,1,1] neg_lo:[0,1,0] neg_hi:[0,1,0]
    v_cvt_pk_bf16_f32 v225, v130, v131
    v_cvt_pk_bf16_f32 v233, v146, v147
    v_pk_fma_f32 v[132:133], v[26:27], v[212:213], v[132:133] op_sel:[1,0,0] op_sel_hi:[0,1,1]
    v_pk_fma_f32 v[148:149], v[26:27], v[196:197], v[148:149] op_sel:[1,0,0] op_sel_hi:[0,1,1] neg_lo:[0,1,0] neg_hi:[0,1,0]
    v_cvt_pk_bf16_f32 v226, v132, v133
    v_cvt_pk_bf16_f32 v234, v148, v149
    v_pk_fma_f32 v[134:135], v[24:25], v[214:215], v[134:135] op_sel:[1,0,0] op_sel_hi:[0,1,1]
    v_pk_fma_f32 v[150:151], v[24:25], v[198:199], v[150:151] op_sel:[1,0,0] op_sel_hi:[0,1,1] neg_lo:[0,1,0] neg_hi:[0,1,0]
    v_cvt_pk_bf16_f32 v227, v134, v135
    v_cvt_pk_bf16_f32 v235, v150, v151
    v_pk_fma_f32 v[136:137], v[254:255], v[216:217], v[136:137] op_sel:[1,0,0] op_sel_hi:[0,1,1]
    v_pk_fma_f32 v[152:153], v[254:255], v[200:201], v[152:153] op_sel:[1,0,0] op_sel_hi:[0,1,1] neg_lo:[0,1,0] neg_hi:[0,1,0]
    v_cvt_pk_bf16_f32 v228, v136, v137
    v_cvt_pk_bf16_f32 v236, v152, v153
    v_pk_fma_f32 v[138:139], v[252:253], v[218:219], v[138:139] op_sel:[1,0,0] op_sel_hi:[0,1,1]
    v_pk_fma_f32 v[154:155], v[252:253], v[202:203], v[154:155] op_sel:[1,0,0] op_sel_hi:[0,1,1] neg_lo:[0,1,0] neg_hi:[0,1,0]
    v_cvt_pk_bf16_f32 v229, v138, v139
    v_cvt_pk_bf16_f32 v237, v154, v155
    v_pk_fma_f32 v[140:141], v[250:251], v[220:221], v[140:141] op_sel:[1,0,0] op_sel_hi:[0,1,1]
    v_pk_fma_f32 v[156:157], v[250:251], v[204:205], v[156:157] op_sel:[1,0,0] op_sel_hi:[0,1,1] neg_lo:[0,1,0] neg_hi:[0,1,0]
    v_cvt_pk_bf16_f32 v230, v140, v141
    v_cvt_pk_bf16_f32 v238, v156, v157
    v_pk_fma_f32 v[142:143], v[248:249], v[222:223], v[142:143] op_sel:[1,0,0] op_sel_hi:[0,1,1]
    v_pk_fma_f32 v[158:159], v[248:249], v[206:207], v[158:159] op_sel:[1,0,0] op_sel_hi:[0,1,1] neg_lo:[0,1,0] neg_hi:[0,1,0]
    v_cvt_pk_bf16_f32 v231, v142, v143
    v_cvt_pk_bf16_f32 v239, v158, v159
    s_cmp_lg_u32 s40, 0
    s_cbranch_scc1 L_spA_r
    s_branch L_pse_11
L_li1:
    v_mfma_f32_32x32x16_bf16 v[128:143], v[224:227], a[0:3], 0
    v_mov_b32 v28, -1
    v_mov_b32 v29, -1
    v_mfma_f32_32x32x16_bf16 v[144:159], v[232:235], a[0:3], 0
    v_mov_b32 v30, -1
    v_mov_b32_e64 v31, -1
    v_mfma_f32_32x32x16_bf16 v[128:143], v[232:235], a[16:19], v[128:143]
    s_add_u32 s47, s60, 6291456
    buffer_store_dwordx4 v[28:31], v6, s[12:15], s47 offen sc1
    v_mfma_f32_32x32x16_bf16 v[144:159], v[224:227], a[8:11], v[144:159]
    s_add_u32 s47, s60, 6295552
    buffer_store_dwordx4 v[28:31], v6, s[12:15], s47 offen sc1
    v_mfma_f32_32x32x16_bf16 v[128:143], v[228:231], a[4:7], v[128:143]
    s_add_u32 s47, s58, 20979712
    buffer_store_dwordx4 v[28:31], v6, s[12:15], s47 offen sc1
    v_mfma_f32_32x32x16_bf16 v[144:159], v[236:239], a[4:7], v[144:159]
    s_add_u32 s47, s58, 20983808
    buffer_store_dwordx4 v[28:31], v6, s[12:15], s47 offen sc1
    v_mfma_f32_32x32x16_bf16 v[128:143], v[236:239], a[20:23], v[128:143]
    v_mfma_f32_32x32x16_bf16 v[144:159], v[228:231], a[12:15], v[144:159]
    s_nop 7
    s_nop 2
    s_branch L_li1_r
L_pb_19_s:
    s_add_u32 s46, s46, 1
    s_cmp_ge_u32 s46, 262144
    s_cbranch_scc1 L_fail
    s_mov_b64 exec, vcc
    s_branch L_pb_19
L_pb_22_s:
    s_add_u32 s46, s46, 1
    s_cmp_ge_u32 s46, 262144
    s_cbranch_scc1 L_fail
    s_mov_b64 exec, vcc
    s_branch L_pb_22
L_pb_24_s:
    s_add_u32 s46, s46, 1
    s_cmp_ge_u32 s46, 262144
    s_cbranch_scc1 L_fail
    s_mov_b64 exec, vcc
    s_branch L_pb_24
L_fail:
    s_mov_b64 exec, -1
    s_waitcnt vmcnt(0) lgkmcnt(0)
L_end:
    s_endpgm
.section .rodata,"a"
.p2align 6
.amdhsa_kernel interleave_layers__spectral_gfnet__spectral_gfnet__prompt_kernel
  .amdhsa_next_free_vgpr 512
  .amdhsa_next_free_sgpr 96
  .amdhsa_accum_offset 256
  .amdhsa_group_segment_fixed_size 0
  .amdhsa_kernarg_size 72
  .amdhsa_user_sgpr_count 2
  .amdhsa_user_sgpr_kernarg_segment_ptr 1
  .amdhsa_system_sgpr_workgroup_id_x 1
.end_amdhsa_kernel
```
